```python
import torch

def _softmax(x, axis=-1):
    return torch.softmax(x, dim=axis)
def _gelu(x):
    return torch.nn.functional.gelu(x, approximate="tanh")
def _silu(x):
    return torch.nn.functional.silu(x)
def _sigmoid(x):
    return torch.sigmoid(x)
def _layernorm(x, axis=-1, eps=1e-5):
    m = x.mean(dim=axis, keepdim=True)
    v = x.var(dim=axis, keepdim=True, unbiased=False)
    return (x - m) / torch.sqrt(v + eps)
def _scatter_add(tgt, idx, src, axis=0):
    return tgt.clone().index_add_(axis, idx, src)
def _segment_sum(src, seg, n):
    out = torch.zeros((n,) + src.shape[1:], dtype=src.dtype)
    return out.index_add_(0, seg, src)
def _pad(x, pw):
    flat = tuple(v for pair in reversed(pw) for v in pair)
    return torch.nn.functional.pad(x, flat)

kernel_name = 'sequential_preLN__gqa_block_cached__mixer_token_mlp__decode'

def setup_inputs():

    _w = (lambda a: (lambda t: t.to(torch.bfloat16) if t.is_floating_point() else t)(torch.as_tensor(a)))
    def _A_setup():
        B, Sq, D = 2, 1, 576
        Hq, Hkv, Sk, Dh = 32, 16, 8192, 128
        assert Hq % Hkv == 0, (Hq, Hkv)
        return {
            "x": _w((lambda *s: torch.randn(*s, dtype=torch.bfloat16) * 0.1)(B, Sq, D)),
            "k_cache": _w((lambda *s: torch.randn(*s, dtype=torch.bfloat16) * 1.6)(B, Hkv, Sk, Dh)),
            "v_cache": _w((lambda *s: torch.randn(*s, dtype=torch.bfloat16) * 1.6)(B, Hkv, Sk, Dh)),
            "wq": _w((lambda *s: torch.randn(*s, dtype=torch.bfloat16) * 1.6)(D, Hq * Dh) * (D ** -0.5)),
            "wo": _w((lambda *s: torch.randn(*s, dtype=torch.bfloat16) * 1.6)(Hq * Dh, D) * ((Hq * Dh) ** -0.5)),
        }
    _A_in = _A_setup()

    def _B_setup():
        B, S, D, F = 2, 1, 576, 4608
        return {
            "x": _w((lambda *s: torch.randn(*s, dtype=torch.bfloat16) * 0.1)(B, S, D)),
            "w1": _w((lambda *s: torch.randn(*s, dtype=torch.bfloat16) * 3.2)(S, F) * (S ** -0.5)),
            "b1": _w((lambda *s: torch.randn(*s, dtype=torch.bfloat16) * 3.2)(F) * 0.02),
            "w2": _w((lambda *s: torch.randn(*s, dtype=torch.bfloat16) * 0.8)(F, S) * (F ** -0.5)),
            "b2": _w((lambda *s: torch.randn(*s, dtype=torch.bfloat16) * 0.8)(S) * 0.02),
        }
    _B_in = _B_setup()

    return {
        "A_x": _A_in["x"],
        "A_k_cache": _A_in["k_cache"],
        "A_v_cache": _A_in["v_cache"],
        "A_wq": _A_in["wq"],
        "A_wo": _A_in["wo"],
        "B_x": _B_in["x"],
        "B_w1": _B_in["w1"],
        "B_b1": _B_in["b1"],
        "B_w2": _B_in["w2"],
        "B_b2": _B_in["b2"],
    }

def reference(A_x, A_k_cache, A_v_cache, A_wq, A_wo, B_x, B_w1, B_b1, B_w2, B_b2):
    def _A_ref(x, k_cache, v_cache, wq, wo):
        B, Sq, D = x.shape
        Hq, Dh = 32, 128
        Hkv = k_cache.shape[1]
        rep = Hq // Hkv
        q = (lambda x, *d: x.permute(*d))((x @ wq).reshape(B, Sq, Hq, Dh), 0, 2, 1, 3)
        k = (lambda x, n, axis: torch.repeat_interleave(x, n, dim=axis))(k_cache, rep, axis=1)
        v = (lambda x, n, axis: torch.repeat_interleave(x, n, dim=axis))(v_cache, rep, axis=1)
        scores = torch.einsum("bhqd,bhkd->bhqk", q, k) * (Dh ** -0.5)
        p = _softmax(scores, axis=-1)
        o = torch.einsum("bhqk,bhkd->bhqd", p, v)
        return (lambda x, *d: x.permute(*d))(o, 0, 2, 1, 3).reshape(B, Sq, Hq * Dh) @ wo

    def _B_ref(x, w1, b1, w2, b2):
        B, S, D = x.shape
        h = _layernorm(x, axis=-1)
        u = torch.einsum("bsd,sf->bdf", h, w1) + b1
        u = _gelu(u)
        y = torch.einsum("bdf,fs->bds", u, w2) + b2
        return (lambda x, *d: x.permute(*d))(y, 0, 2, 1)

    x = A_x
    h = x + _A_ref(_layernorm(x, axis=-1), A_k_cache, A_v_cache, A_wq, A_wo)
    h2 = h + _B_ref(_layernorm(h, axis=-1), B_w1, B_b1, B_w2, B_b2)
    return h2
```

```asm
; @launch grid=(256,1,1) block=(512,1,1) lds=156928
.amdgcn_target "amdgcn-amd-amdhsa--gfx950"
.text
.globl sequential_preLN__gqa_block_cached__mixer_token_mlp__decode_kernel
.p2align 8
.type sequential_preLN__gqa_block_cached__mixer_token_mlp__decode_kernel,@function
sequential_preLN__gqa_block_cached__mixer_token_mlp__decode_kernel:
    s_cmp_ge_u32 s2, 256
    s_cbranch_scc1 L_end
    s_load_dwordx16 s[16:31], s[0:1], 0
    s_load_dwordx8 s[32:39], s[0:1], 64
    s_load_dwordx2 s[40:41], s[0:1], 96
    v_lshrrev_b32 v1, 6, v0
    v_and_b32 v0, 63, v0
    s_lshr_b32 s42, s2, 7
    v_readfirstlane_b32 s3, v1
    s_and_b32 s43, s2, 15
    s_bfe_u32 s44, s2, 0x30004
    s_lshl_b32 s2, s42, 4
    s_add_u32 s2, s2, s43
    s_lshl_b32 s2, s2, 3
    s_add_u32 s2, s2, s44
    v_mov_b32 v4, 0
    v_mov_b32 v5, 0
    v_mov_b32 v6, 0
    v_mov_b32 v7, 0
    v_mov_b32 v66, 4
    v_mov_b32 v64, 0
    v_mov_b32 v65, 0
    ds_write_b128 v4, v[4:7] offset:512
    ds_write_b96 v4, v[64:66] offset:528
    s_mov_b32 s7, 0x20000
    s_mov_b32 s11, 0x20000
    s_cmp_eq_u32 s3, 4
    s_cbranch_scc1 L_h0_start
    s_and_b32 s48, s43, 7
    s_cmp_gt_u32 s44, s48
    s_cselect_b32 s50, 1, 0
    s_sub_u32 s51, s44, s50
    s_mul_i32 s52, s50, 52
    s_min_u32 s50, s51, 5
    s_cmp_lt_u32 s51, 5
    s_cselect_b32 s49, 1, 0
    s_add_u32 s49, s49, 65
    s_mul_i32 s51, s51, 65
    s_add_u32 s51, s51, s50
    s_add_u32 s51, s51, s52
    s_cmp_eq_u32 s44, s48
    s_cselect_b32 s49, 52, s49
    s_lshr_b32 s52, s2, 3
    s_lshl_b32 s52, s52, 9
    s_add_u32 s52, s52, s51
    s_add_u32 s6, s52, s49
    s_lshl_b32 s6, s6, 12
    s_mov_b32 s10, s6
    s_lshl_b32 s51, s52, 12
    s_add_u32 s52, s52, s3
    s_lshl_b32 s52, s52, 12
    v_lshlrev_b32 v2, 4, v0
    v_lshrrev_b32 v1, 4, v0
    v_lshlrev_b32 v1, 6, v1
    v_xor_b32 v60, v2, v1
    v_xor_b32 v61, 16, v60
    v_xor_b32 v62, 32, v60
    v_xor_b32 v63, 48, v60
    s_lshl_b32 s56, s3, 15
    s_add_u32 s56, s56, 7424
    s_cmp_gt_u32 s3, 4
    s_waitcnt lgkmcnt(0)
    s_mov_b32 s4, s18
    s_mov_b32 s5, s19
    s_mov_b32 s8, s20
    s_mov_b32 s9, s21
    s_barrier
    s_cbranch_scc1 L_join
    s_add_u32 m0, s56, 0
    s_nop 0
    buffer_load_dwordx4 v60, s[4:7], s52 offen offset:0 nt lds
    buffer_load_dwordx4 v61, s[4:7], s52 offen offset:1024 nt lds
    buffer_load_dwordx4 v62, s[4:7], s52 offen offset:2048 nt lds
    buffer_load_dwordx4 v63, s[4:7], s52 offen offset:3072 nt lds
    s_branch L_join
L_h0_start:
    s_setprio 3
    v_mov_b32 v2, 0
    v_mov_b32 v60, 0
    v_mov_b32 v61, 0
    v_mov_b32 v62, 0
    v_mov_b32 v63, 0
    v_lshrrev_b32 v8, 5, v0
    v_mul_u32_u24 v8, 1152, v8
    v_and_b32 v10, 31, v0
    v_mul_u32_u24 v10, 36, v10
    v_add_u32 v8, v8, v10
    v_lshrrev_b32 v9, 4, v0
    v_mul_u32_u24 v9, 147456, v9
    v_and_b32 v10, 15, v0
    v_lshl_add_u32 v9, v10, 4, v9
    s_lshl_b32 s48, s43, 1
    s_add_u32 s48, s48, s42
    s_lshl_b32 s48, s48, 8
    s_mul_i32 s49, s44, 589824
    s_add_u32 s48, s48, s49
    s_mov_b32 s6, 2304
    s_mov_b32 s10, 4718592
    s_waitcnt lgkmcnt(0)
    s_mov_b32 s4, s16
    s_mov_b32 s5, s17
    s_mov_b32 s8, s22
    s_mov_b32 s9, s23
    buffer_load_dwordx4 v[12:15], v8, s[4:7], 0 offen
    buffer_load_dwordx4 v[16:19], v8, s[4:7], 0 offen offset:16
    buffer_load_dword v20, v8, s[4:7], 0 offen offset:32
    buffer_load_dwordx4 v[96:99], v9, s[8:11], s48 offen nt
    s_add_u32 s48, s48, 8192
    buffer_load_dwordx4 v[100:103], v9, s[8:11], s48 offen nt
    s_add_u32 s48, s48, 8192
    buffer_load_dwordx4 v[104:107], v9, s[8:11], s48 offen nt
    s_add_u32 s48, s48, 8192
    buffer_load_dwordx4 v[108:111], v9, s[8:11], s48 offen nt
    s_add_u32 s48, s48, 8192
    buffer_load_dwordx4 v[112:115], v9, s[8:11], s48 offen nt
    s_add_u32 s48, s48, 8192
    buffer_load_dwordx4 v[116:119], v9, s[8:11], s48 offen nt
    s_add_u32 s48, s48, 8192
    buffer_load_dwordx4 v[120:123], v9, s[8:11], s48 offen nt
    s_add_u32 s48, s48, 8192
    buffer_load_dwordx4 v[124:127], v9, s[8:11], s48 offen nt
    s_add_u32 s48, s48, 8192
    buffer_load_dwordx4 v[128:131], v9, s[8:11], s48 offen nt
    s_add_u32 s48, s48, 8192
    buffer_load_dwordx4 v[132:135], v9, s[8:11], s48 offen nt
    s_add_u32 s48, s48, 8192
    buffer_load_dwordx4 v[136:139], v9, s[8:11], s48 offen nt
    s_add_u32 s48, s48, 8192
    buffer_load_dwordx4 v[140:143], v9, s[8:11], s48 offen nt
    s_add_u32 s48, s48, 8192
    buffer_load_dwordx4 v[144:147], v9, s[8:11], s48 offen nt
    s_add_u32 s48, s48, 8192
    buffer_load_dwordx4 v[148:151], v9, s[8:11], s48 offen nt
    s_add_u32 s48, s48, 8192
    buffer_load_dwordx4 v[152:155], v9, s[8:11], s48 offen nt
    s_add_u32 s48, s48, 8192
    buffer_load_dwordx4 v[156:159], v9, s[8:11], s48 offen nt
    s_add_u32 s48, s48, 8192
    buffer_load_dwordx4 v[160:163], v9, s[8:11], s48 offen nt
    s_add_u32 s48, s48, 8192
    buffer_load_dwordx4 v[164:167], v9, s[8:11], s48 offen nt
    s_barrier
    s_load_dword s55, s[40:41], 0
L_join:
    s_and_b32 s48, s43, 7
    s_cmp_eq_u32 s44, s48
    s_cselect_b32 s45, 1, 0
    s_mov_b32 s14, 2097152
    s_mov_b32 s15, 0x20000
    s_mov_b32 s46, 0
    s_cmp_eq_u32 s2, 4
    s_cselect_b32 s46, 1, s46
    s_cmp_eq_u32 s2, 133
    s_cselect_b32 s46, 2, s46
    s_mov_b32 s60, 0x00ff00ff
    s_mov_b32 s61, 0xff00ff00
    s_mov_b32 s62, 0x3fb8aa3b
    s_mov_b32 s63, 0x3db504f3
    s_mov_b32 s64, 0x07060501
    s_mov_b32 s65, 0x07060502
    s_mov_b32 s66, 0x07060503
    s_mov_b32 s67, 0x04000c0c
    s_mov_b32 s68, 0x0706000c
    s_mov_b32 s98, 0
    s_mov_b32 s12, s40
    s_mov_b32 s13, s41
    s_cmp_lt_u32 s3, 4
    s_cbranch_scc1 L_stream
    s_setprio 3
    s_sub_u32 s56, s3, 4
    s_load_dword s69, s[34:35], 0
    s_cmp_eq_u32 s56, 0
    s_cbranch_scc1 L_qphase
    s_getpc_b64 s[50:51]
L_pc:
    s_sub_u32 s50, s50, L_pc-sequential_preLN__gqa_block_cached__mixer_token_mlp__decode_kernel
    s_subb_u32 s51, s51, 0
    s_sub_u32 s48, s56, 1
    s_lshl_b32 s48, s48, 13
    v_lshlrev_b32 v1, 7, v0
    v_add_u32 v1, s48, v1
    v_min_u32 v1, L_code_end-sequential_preLN__gqa_block_cached__mixer_token_mlp__decode_kernel-4, v1
    global_load_dword v8, v1, s[50:51]
    s_cmp_eq_u32 s45, 0
    s_cbranch_scc1 L_nowo_a
    s_mov_b32 s8, s24
    s_mov_b32 s9, s25
    s_mov_b32 s10, 4718592
    s_mov_b32 s11, 0x20000
    s_lshl_b32 s48, s43, 1
    s_add_u32 s48, s48, s42
    s_mul_i32 s48, s48, 147456
    s_mul_i32 s49, s56, 36864
    s_add_u32 s48, s48, s49
    v_lshrrev_b32 v1, 5, v0
    v_bfe_u32 v2, v0, 4, 1
    v_lshl_add_u32 v1, v1, 2, v2
    v_mul_u32_u24 v1, 1152, v1
    v_and_b32 v2, 15, v0
    v_lshl_add_u32 v1, v2, 4, v1
    s_add_u32 s49, s48, 0
    buffer_load_dwordx4 v[96:99], v1, s[8:11], s49 offen offset:0 nt
    buffer_load_dwordx4 v[104:107], v1, s[8:11], s49 offen offset:256 nt
    buffer_load_dwordx4 v[112:115], v1, s[8:11], s49 offen offset:512 nt
    buffer_load_dwordx4 v[120:123], v1, s[8:11], s49 offen offset:768 nt
    s_add_u32 s49, s48, 9216
    buffer_load_dwordx4 v[100:103], v1, s[8:11], s49 offen offset:0 nt
    buffer_load_dwordx4 v[108:111], v1, s[8:11], s49 offen offset:256 nt
    buffer_load_dwordx4 v[116:119], v1, s[8:11], s49 offen offset:512 nt
    buffer_load_dwordx4 v[124:127], v1, s[8:11], s49 offen offset:768 nt
    s_add_u32 s49, s48, 2304
    buffer_load_dwordx4 v[136:139], v1, s[8:11], s49 offen offset:0 nt
    buffer_load_dwordx4 v[144:147], v1, s[8:11], s49 offen offset:256 nt
    buffer_load_dwordx4 v[152:155], v1, s[8:11], s49 offen offset:512 nt
    buffer_load_dwordx4 v[160:163], v1, s[8:11], s49 offen offset:768 nt
    s_add_u32 s49, s48, 11520
    buffer_load_dwordx4 v[140:143], v1, s[8:11], s49 offen offset:0 nt
    buffer_load_dwordx4 v[148:151], v1, s[8:11], s49 offen offset:256 nt
    buffer_load_dwordx4 v[156:159], v1, s[8:11], s49 offen offset:512 nt
    buffer_load_dwordx4 v[164:167], v1, s[8:11], s49 offen offset:768 nt
    s_add_u32 s49, s48, 18432
    buffer_load_dwordx4 v[176:179], v1, s[8:11], s49 offen offset:0 nt
    buffer_load_dwordx4 v[184:187], v1, s[8:11], s49 offen offset:256 nt
    buffer_load_dwordx4 v[192:195], v1, s[8:11], s49 offen offset:512 nt
    buffer_load_dwordx4 v[200:203], v1, s[8:11], s49 offen offset:768 nt
    s_add_u32 s49, s48, 27648
    buffer_load_dwordx4 v[180:183], v1, s[8:11], s49 offen offset:0 nt
    buffer_load_dwordx4 v[188:191], v1, s[8:11], s49 offen offset:256 nt
    buffer_load_dwordx4 v[196:199], v1, s[8:11], s49 offen offset:512 nt
    buffer_load_dwordx4 v[204:207], v1, s[8:11], s49 offen offset:768 nt
    s_add_u32 s49, s48, 20736
    buffer_load_dwordx4 v[216:219], v1, s[8:11], s49 offen offset:0 nt
    buffer_load_dwordx4 v[224:227], v1, s[8:11], s49 offen offset:256 nt
    buffer_load_dwordx4 v[232:235], v1, s[8:11], s49 offen offset:512 nt
    buffer_load_dwordx4 v[240:243], v1, s[8:11], s49 offen offset:768 nt
    s_add_u32 s49, s48, 29952
    buffer_load_dwordx4 v[220:223], v1, s[8:11], s49 offen offset:0 nt
    buffer_load_dwordx4 v[228:231], v1, s[8:11], s49 offen offset:256 nt
    buffer_load_dwordx4 v[236:239], v1, s[8:11], s49 offen offset:512 nt
    buffer_load_dwordx4 v[244:247], v1, s[8:11], s49 offen offset:768 nt
    s_mov_b32 exec_lo, 0x00ff00ff
    s_mov_b32 exec_hi, 0x00ff00ff
    s_add_u32 s49, s48, 0
    buffer_load_dwordx4 v[128:131], v1, s[8:11], s49 offen offset:1024 nt
    s_add_u32 s49, s48, 9216
    buffer_load_dwordx4 v[132:135], v1, s[8:11], s49 offen offset:1024 nt
    s_add_u32 s49, s48, 2304
    buffer_load_dwordx4 v[168:171], v1, s[8:11], s49 offen offset:1024 nt
    s_add_u32 s49, s48, 11520
    buffer_load_dwordx4 v[172:175], v1, s[8:11], s49 offen offset:1024 nt
    s_add_u32 s49, s48, 18432
    buffer_load_dwordx4 v[208:211], v1, s[8:11], s49 offen offset:1024 nt
    s_add_u32 s49, s48, 27648
    buffer_load_dwordx4 v[212:215], v1, s[8:11], s49 offen offset:1024 nt
    s_add_u32 s49, s48, 20736
    buffer_load_dwordx4 v[248:251], v1, s[8:11], s49 offen offset:1024 nt
    s_add_u32 s49, s48, 29952
    buffer_load_dwordx4 v[252:255], v1, s[8:11], s49 offen offset:1024 nt
    s_mov_b64 exec, -1
    s_branch L_pre_b2
L_nowo_a:
    s_mul_i32 s48, s56, 2560
    s_sub_u32 s48, s48, 1024
    v_lshlrev_b32 v1, 4, v0
    v_lshlrev_b32 v2, 3, v0
    s_mov_b32 s4, s28
    s_mov_b32 s5, s29
    s_mov_b32 s6, 9216
    s_mov_b32 s7, 0x20000
    buffer_load_dwordx4 v[46:49], v1, s[4:7], s48 offen offset:0
    buffer_load_dwordx4 v[50:53], v1, s[4:7], s48 offen offset:1024
    buffer_load_dwordx2 v[54:55], v2, s[4:7], s48 offen offset:2048
    s_mov_b32 s4, s30
    s_mov_b32 s5, s31
    s_mov_b32 s6, 9216
    s_mov_b32 s7, 0x20000
    buffer_load_dwordx4 v[66:69], v1, s[4:7], s48 offen offset:0
    buffer_load_dwordx4 v[70:73], v1, s[4:7], s48 offen offset:1024
    buffer_load_dwordx2 v[74:75], v2, s[4:7], s48 offen offset:2048
    s_mov_b32 s4, s32
    s_mov_b32 s5, s33
    s_mov_b32 s6, 9216
    s_mov_b32 s7, 0x20000
    buffer_load_dwordx4 v[86:89], v1, s[4:7], s48 offen offset:0
    buffer_load_dwordx4 v[90:93], v1, s[4:7], s48 offen offset:1024
    buffer_load_dwordx2 v[94:95], v2, s[4:7], s48 offen offset:2048
    s_waitcnt vmcnt(0)
    v_lshlrev_b32 v36, 16, v46
    v_and_b32 v37, 0xffff0000, v46
    v_lshlrev_b32 v38, 16, v47
    v_and_b32 v39, 0xffff0000, v47
    v_lshlrev_b32 v40, 16, v48
    v_and_b32 v41, 0xffff0000, v48
    v_lshlrev_b32 v42, 16, v49
    v_and_b32 v43, 0xffff0000, v49
    v_lshlrev_b32 v44, 16, v50
    v_and_b32 v45, 0xffff0000, v50
    v_lshlrev_b32 v46, 16, v51
    v_and_b32 v47, 0xffff0000, v51
    v_lshlrev_b32 v48, 16, v52
    v_and_b32 v49, 0xffff0000, v52
    v_lshlrev_b32 v50, 16, v53
    v_and_b32 v51, 0xffff0000, v53
    v_lshlrev_b32 v52, 16, v54
    v_and_b32 v53, 0xffff0000, v54
    v_lshlrev_b32 v54, 16, v55
    v_and_b32 v55, 0xffff0000, v55
    v_lshlrev_b32 v56, 16, v66
    v_and_b32 v57, 0xffff0000, v66
    v_lshlrev_b32 v58, 16, v67
    v_and_b32 v59, 0xffff0000, v67
    v_lshlrev_b32 v60, 16, v68
    v_and_b32 v61, 0xffff0000, v68
    v_lshlrev_b32 v62, 16, v69
    v_and_b32 v63, 0xffff0000, v69
    v_lshlrev_b32 v64, 16, v70
    v_and_b32 v65, 0xffff0000, v70
    v_lshlrev_b32 v66, 16, v71
    v_and_b32 v67, 0xffff0000, v71
    v_lshlrev_b32 v68, 16, v72
    v_and_b32 v69, 0xffff0000, v72
    v_lshlrev_b32 v70, 16, v73
    v_and_b32 v71, 0xffff0000, v73
    v_lshlrev_b32 v72, 16, v74
    v_and_b32 v73, 0xffff0000, v74
    v_lshlrev_b32 v74, 16, v75
    v_and_b32 v75, 0xffff0000, v75
    v_lshlrev_b32 v76, 16, v86
    v_and_b32 v77, 0xffff0000, v86
    v_lshlrev_b32 v78, 16, v87
    v_and_b32 v79, 0xffff0000, v87
    v_lshlrev_b32 v80, 16, v88
    v_and_b32 v81, 0xffff0000, v88
    v_lshlrev_b32 v82, 16, v89
    v_and_b32 v83, 0xffff0000, v89
    v_lshlrev_b32 v84, 16, v90
    v_and_b32 v85, 0xffff0000, v90
    v_lshlrev_b32 v86, 16, v91
    v_and_b32 v87, 0xffff0000, v91
    v_lshlrev_b32 v88, 16, v92
    v_and_b32 v89, 0xffff0000, v92
    v_lshlrev_b32 v90, 16, v93
    v_and_b32 v91, 0xffff0000, v93
    v_lshlrev_b32 v92, 16, v94
    v_and_b32 v93, 0xffff0000, v94
    v_lshlrev_b32 v94, 16, v95
    v_and_b32 v95, 0xffff0000, v95
    s_nop 0
    s_branch L_table
L_stream:
    v_mov_b32 v56, 0
    v_mov_b32 v59, 1
    s_mov_b64 exec, 1
    ds_add_rtn_u32 v57, v56, v59 offset:536
    s_mov_b64 exec, -1
    s_mov_b32 s54, 1
    s_waitcnt lgkmcnt(0)
    v_readfirstlane_b32 s48, v57
    s_mov_b32 s96, s52
    s_mov_b64 exec, 1
    ds_add_rtn_u32 v57, v56, v59 offset:536
    s_mov_b64 exec, -1
    s_lshl_b32 s52, s48, 12
    s_add_u32 s52, s52, s51
    s_cmp_lt_u32 s48, s49
    s_addc_u32 s54, s54, 0
    s_add_u32 m0, s56, 4096
    s_nop 0
    buffer_load_dwordx4 v60, s[4:7], s52 offen offset:0 nt lds
    buffer_load_dwordx4 v61, s[4:7], s52 offen offset:1024 nt lds
    buffer_load_dwordx4 v62, s[4:7], s52 offen offset:2048 nt lds
    buffer_load_dwordx4 v63, s[4:7], s52 offen offset:3072 nt lds
    buffer_load_dwordx4 v[128:131], v2, s[8:11], s96 offen offset:0 nt
    buffer_load_dwordx4 v[132:135], v2, s[8:11], s96 offen offset:1024 nt
    buffer_load_dwordx4 v[136:139], v2, s[8:11], s96 offen offset:2048 nt
    buffer_load_dwordx4 v[140:143], v2, s[8:11], s96 offen offset:3072 nt
    s_waitcnt vmcnt(4)
    s_waitcnt lgkmcnt(0)
    v_readfirstlane_b32 s48, v57
    s_mov_b32 s96, s52
    s_mov_b64 exec, 1
    ds_add_rtn_u32 v57, v56, v59 offset:536
    s_mov_b64 exec, -1
    s_lshl_b32 s52, s48, 12
    s_add_u32 s52, s52, s51
    s_cmp_lt_u32 s48, s49
    s_addc_u32 s54, s54, 0
    s_add_u32 m0, s56, 8192
    s_nop 0
    buffer_load_dwordx4 v60, s[4:7], s52 offen offset:0 nt lds
    buffer_load_dwordx4 v61, s[4:7], s52 offen offset:1024 nt lds
    buffer_load_dwordx4 v62, s[4:7], s52 offen offset:2048 nt lds
    buffer_load_dwordx4 v63, s[4:7], s52 offen offset:3072 nt lds
    s_waitcnt vmcnt(4)
    buffer_load_dwordx4 v[144:147], v2, s[8:11], s96 offen offset:0 nt
    buffer_load_dwordx4 v[148:151], v2, s[8:11], s96 offen offset:1024 nt
    buffer_load_dwordx4 v[152:155], v2, s[8:11], s96 offen offset:2048 nt
    buffer_load_dwordx4 v[156:159], v2, s[8:11], s96 offen offset:3072 nt
    v_and_b32 v18, 1, v0
    v_cmp_eq_u32 vcc, 1, v18
    v_mov_b32 v18, 0xffff
    v_mov_b32 v19, 0xffff0000
    v_cndmask_b32 v18, v18, v19, vcc
    v_bfe_u32 v19, v0, 1, 2
    v_cmp_eq_u32 vcc, 0, v19
    s_nop 1
    v_cndmask_b32 v4, 0, v18, vcc
    v_cmp_eq_u32 vcc, 1, v19
    s_nop 1
    v_cndmask_b32 v5, 0, v18, vcc
    v_cmp_eq_u32 vcc, 2, v19
    s_nop 1
    v_cndmask_b32 v6, 0, v18, vcc
    v_cmp_eq_u32 vcc, 3, v19
    s_nop 1
    v_cndmask_b32 v7, 0, v18, vcc
    v_mov_b32 v8, 0
    v_mov_b32 v9, 0
    v_mov_b32 v10, 0
    v_mov_b32 v11, 0
    v_mov_b32 v16, 0xff7fffff
    v_mov_b32 v17, 0
    v_bfe_u32 v3, v0, 3, 1
    v_lshlrev_b32 v3, 8, v3
    v_lshrrev_b32 v18, 4, v0
    v_lshl_add_u32 v3, v18, 4, v3
    v_and_b32 v19, 15, v0
    v_xor_b32 v18, v18, v19
    v_lshlrev_b32 v18, 4, v18
    v_and_b32 v19, 3, v0
    v_lshl_add_u32 v18, v19, 10, v18
    v_bfe_u32 v19, v0, 2, 2
    v_lshl_add_u32 v18, v19, 8, v18
    v_xor_b32 v80, 0, v18
    v_xor_b32 v81, 64, v18
    v_xor_b32 v82, 128, v18
    v_xor_b32 v83, 192, v18
    v_add_u32 v80, s56, v80
    v_add_u32 v81, s56, v81
    v_add_u32 v82, s56, v82
    v_add_u32 v83, s56, v83
    s_lshl_b32 s48, s3, 10
    v_add_u32 v84, s48, v2
    v_lshlrev_b32 v87, 3, v0
    s_lshl_b32 s48, s3, 9
    v_add_u32 v85, s48, v87
    s_mul_i32 s57, s43, 20480
    s_lshl_b32 s48, s44, 4
    s_add_u32 s57, s57, s48
    s_add_u32 s57, s57, 393216
    v_lshrrev_b32 v88, 5, v0
    v_mul_u32_u24 v88, 10240, v88
    v_and_b32 v89, 15, v0
    v_lshl_add_u32 v89, v89, 8, v88
    v_bfe_u32 v18, v0, 4, 1
    v_lshl_add_u32 v89, v18, 7, v89
    s_lshl_b32 s48, s42, 12
    v_add_u32 v89, s48, v89
    s_lshl_b32 s48, s42, 7
    s_add_u32 s48, s48, 8192
    v_add_u32 v88, s48, v88
    v_mov_b32 v18, 0
    s_waitcnt vmcnt(4)
    s_waitcnt lgkmcnt(0)
    v_readfirstlane_b32 s48, v57
    s_mov_b32 s96, s52
    s_mov_b64 exec, 1
    ds_add_rtn_u32 v57, v56, v59 offset:536
    s_mov_b64 exec, -1
    s_lshl_b32 s52, s48, 12
    s_add_u32 s52, s52, s51
    s_cmp_lt_u32 s48, s49
    s_addc_u32 s54, s54, 0
    s_add_u32 m0, s56, 12288
    s_nop 0
    buffer_load_dwordx4 v60, s[4:7], s52 offen offset:0 nt lds
    buffer_load_dwordx4 v61, s[4:7], s52 offen offset:1024 nt lds
    buffer_load_dwordx4 v62, s[4:7], s52 offen offset:2048 nt lds
    buffer_load_dwordx4 v63, s[4:7], s52 offen offset:3072 nt lds
    s_waitcnt vmcnt(4)
    buffer_load_dwordx4 v[160:163], v2, s[8:11], s96 offen offset:0 nt
    buffer_load_dwordx4 v[164:167], v2, s[8:11], s96 offen offset:1024 nt
    buffer_load_dwordx4 v[168:171], v2, s[8:11], s96 offen offset:2048 nt
    buffer_load_dwordx4 v[172:175], v2, s[8:11], s96 offen offset:3072 nt
    s_waitcnt vmcnt(4)
    ds_read_b32 v19, v18 offset:524
    s_mov_b32 s53, 1
    s_waitcnt lgkmcnt(0)
    v_readfirstlane_b32 s48, v19
    s_nop 1
    s_cmp_lg_u32 s48, 0
    s_nop 0
    s_cbranch_scc1 L_qwait_ok
    s_waitcnt lgkmcnt(0)
    v_readfirstlane_b32 s48, v57
    s_mov_b32 s96, s52
    s_mov_b64 exec, 1
    ds_add_rtn_u32 v57, v56, v59 offset:536
    s_mov_b64 exec, -1
    s_lshl_b32 s52, s48, 12
    s_add_u32 s52, s52, s51
    s_cmp_lt_u32 s48, s49
    s_addc_u32 s54, s54, 0
    s_add_u32 m0, s56, 16384
    s_nop 0
    buffer_load_dwordx4 v60, s[4:7], s52 offen offset:0 nt lds
    buffer_load_dwordx4 v61, s[4:7], s52 offen offset:1024 nt lds
    buffer_load_dwordx4 v62, s[4:7], s52 offen offset:2048 nt lds
    buffer_load_dwordx4 v63, s[4:7], s52 offen offset:3072 nt lds
    s_waitcnt vmcnt(4)
    buffer_load_dwordx4 v[176:179], v2, s[8:11], s96 offen offset:0 nt
    buffer_load_dwordx4 v[180:183], v2, s[8:11], s96 offen offset:1024 nt
    buffer_load_dwordx4 v[184:187], v2, s[8:11], s96 offen offset:2048 nt
    buffer_load_dwordx4 v[188:191], v2, s[8:11], s96 offen offset:3072 nt
    s_waitcnt vmcnt(4)
    ds_read_b32 v19, v18 offset:524
    s_mov_b32 s53, 2
    s_waitcnt lgkmcnt(0)
    v_readfirstlane_b32 s48, v19
    s_nop 1
    s_cmp_lg_u32 s48, 0
    s_nop 0
    s_cbranch_scc1 L_qwait_ok
    s_waitcnt lgkmcnt(0)
    v_readfirstlane_b32 s48, v57
    s_mov_b32 s96, s52
    s_mov_b64 exec, 1
    ds_add_rtn_u32 v57, v56, v59 offset:536
    s_mov_b64 exec, -1
    s_lshl_b32 s52, s48, 12
    s_add_u32 s52, s52, s51
    s_cmp_lt_u32 s48, s49
    s_addc_u32 s54, s54, 0
    s_add_u32 m0, s56, 20480
    s_nop 0
    buffer_load_dwordx4 v60, s[4:7], s52 offen offset:0 nt lds
    buffer_load_dwordx4 v61, s[4:7], s52 offen offset:1024 nt lds
    buffer_load_dwordx4 v62, s[4:7], s52 offen offset:2048 nt lds
    buffer_load_dwordx4 v63, s[4:7], s52 offen offset:3072 nt lds
    s_waitcnt vmcnt(4)
    buffer_load_dwordx4 v[192:195], v2, s[8:11], s96 offen offset:0 nt
    buffer_load_dwordx4 v[196:199], v2, s[8:11], s96 offen offset:1024 nt
    buffer_load_dwordx4 v[200:203], v2, s[8:11], s96 offen offset:2048 nt
    buffer_load_dwordx4 v[204:207], v2, s[8:11], s96 offen offset:3072 nt
    s_waitcnt vmcnt(4)
    ds_read_b32 v19, v18 offset:524
    s_mov_b32 s53, 3
    s_waitcnt lgkmcnt(0)
    v_readfirstlane_b32 s48, v19
    s_nop 1
    s_cmp_lg_u32 s48, 0
    s_nop 0
    s_cbranch_scc1 L_qwait_ok
    s_waitcnt lgkmcnt(0)
    v_readfirstlane_b32 s48, v57
    s_mov_b32 s96, s52
    s_mov_b64 exec, 1
    ds_add_rtn_u32 v57, v56, v59 offset:536
    s_mov_b64 exec, -1
    s_lshl_b32 s52, s48, 12
    s_add_u32 s52, s52, s51
    s_cmp_lt_u32 s48, s49
    s_addc_u32 s54, s54, 0
    s_add_u32 m0, s56, 24576
    s_nop 0
    buffer_load_dwordx4 v60, s[4:7], s52 offen offset:0 nt lds
    buffer_load_dwordx4 v61, s[4:7], s52 offen offset:1024 nt lds
    buffer_load_dwordx4 v62, s[4:7], s52 offen offset:2048 nt lds
    buffer_load_dwordx4 v63, s[4:7], s52 offen offset:3072 nt lds
    s_waitcnt vmcnt(4)
    buffer_load_dwordx4 v[208:211], v2, s[8:11], s96 offen offset:0 nt
    buffer_load_dwordx4 v[212:215], v2, s[8:11], s96 offen offset:1024 nt
    buffer_load_dwordx4 v[216:219], v2, s[8:11], s96 offen offset:2048 nt
    buffer_load_dwordx4 v[220:223], v2, s[8:11], s96 offen offset:3072 nt
    s_waitcnt vmcnt(4)
    ds_read_b32 v19, v18 offset:524
    s_mov_b32 s53, 4
    s_waitcnt lgkmcnt(0)
    v_readfirstlane_b32 s48, v19
    s_nop 1
    s_cmp_lg_u32 s48, 0
    s_nop 0
    s_cbranch_scc1 L_qwait_ok
    s_waitcnt lgkmcnt(0)
    v_readfirstlane_b32 s48, v57
    s_mov_b32 s96, s52
    s_mov_b64 exec, 1
    ds_add_rtn_u32 v57, v56, v59 offset:536
    s_mov_b64 exec, -1
    s_lshl_b32 s52, s48, 12
    s_add_u32 s52, s52, s51
    s_cmp_lt_u32 s48, s49
    s_addc_u32 s54, s54, 0
    s_add_u32 m0, s56, 28672
    s_nop 0
    buffer_load_dwordx4 v60, s[4:7], s52 offen offset:0 nt lds
    buffer_load_dwordx4 v61, s[4:7], s52 offen offset:1024 nt lds
    buffer_load_dwordx4 v62, s[4:7], s52 offen offset:2048 nt lds
    buffer_load_dwordx4 v63, s[4:7], s52 offen offset:3072 nt lds
    s_waitcnt vmcnt(4)
    buffer_load_dwordx4 v[224:227], v2, s[8:11], s96 offen offset:0 nt
    buffer_load_dwordx4 v[228:231], v2, s[8:11], s96 offen offset:1024 nt
    buffer_load_dwordx4 v[232:235], v2, s[8:11], s96 offen offset:2048 nt
    buffer_load_dwordx4 v[236:239], v2, s[8:11], s96 offen offset:3072 nt
    s_mov_b32 s53, 5
    s_mov_b32 s50, 0
L_qwait:
    ds_read_b32 v19, v18 offset:524
    s_waitcnt lgkmcnt(0)
    v_readfirstlane_b32 s48, v19
    s_nop 1
    s_cmp_lg_u32 s48, 0
    s_nop 0
    s_cbranch_scc1 L_qwait_ok
    s_sleep 1
    s_add_u32 s50, s50, 1
    s_cmp_lt_u32 s50, 16777216
    s_cbranch_scc1 L_qwait
L_qwait_ok:
L_qskip:
    ds_read_b128 v[40:43], v3 offset:0
    ds_read_b128 v[44:47], v3 offset:64
    ds_read_b128 v[48:51], v3 offset:128
    ds_read_b128 v[52:55], v3 offset:192
    ds_read_b64 v[20:21], v18 offset:512
    ds_read_b32 v22, v18 offset:540
    s_mov_b64 vcc, s[60:61]
    s_waitcnt lgkmcnt(0)
    v_readfirstlane_b32 s99, v22
    v_readfirstlane_b32 s47, v20
    v_readfirstlane_b32 s55, v21
    s_waitcnt vmcnt(16)
    s_setprio 3
    ds_read_b128 v[64:67], v80 offset:0
    ds_read_b128 v[68:71], v81 offset:0
    ds_read_b128 v[72:75], v82 offset:0
    ds_read_b128 v[76:79], v83 offset:0
    s_waitcnt lgkmcnt(3)
    v_mfma_f32_16x16x32_bf16 v[12:15], v[64:67], v[40:43], 0
    s_waitcnt lgkmcnt(2)
    v_mfma_f32_16x16x32_bf16 v[12:15], v[68:71], v[44:47], v[12:15]
    s_waitcnt lgkmcnt(1)
    v_mfma_f32_16x16x32_bf16 v[12:15], v[72:75], v[48:51], v[12:15]
    s_waitcnt lgkmcnt(0)
    v_mfma_f32_16x16x32_bf16 v[12:15], v[76:79], v[52:55], v[12:15]
    s_nop 7
    v_cvt_pk_bf16_f32 v12, 0, v12
    v_cvt_pk_bf16_f32 v13, 0, v13
    v_cvt_pk_bf16_f32 v14, 0, v14
    v_cvt_pk_bf16_f32 v15, 0, v15
    v_mul_f32 v12, s63, v12
    v_mul_f32 v13, s63, v13
    v_mul_f32 v14, s63, v14
    v_mul_f32 v15, s63, v15
    v_cvt_pk_bf16_f32 v12, 0, v12
    v_cvt_pk_bf16_f32 v13, 0, v13
    v_cvt_pk_bf16_f32 v14, 0, v14
    v_cvt_pk_bf16_f32 v15, 0, v15
    v_max3_f32 v18, v12, v13, v14
    v_max3_f32 v18, v18, v15, v16
    v_mov_b32 v19, v18
    s_nop 1
    v_permlane32_swap_b32 v18, v19
    v_max_f32 v18, v18, v19
    v_mov_b32 v19, v18
    s_nop 1
    v_permlane16_swap_b32 v18, v19
    v_max_f32 v18, v18, v19
    v_sub_f32 v20, v16, v18
    v_mul_f32 v21, s62, v18
    v_mul_f32 v20, s62, v20
    v_mov_b32 v16, v18
    v_exp_f32 v20, v20
    v_fma_f32 v12, v12, s62, -v21
    v_fma_f32 v13, v13, s62, -v21
    v_fma_f32 v14, v14, s62, -v21
    v_fma_f32 v15, v15, s62, -v21
    v_exp_f32 v12, v12
    v_exp_f32 v13, v13
    v_exp_f32 v14, v14
    v_exp_f32 v15, v15
    v_cndmask_b32_dpp v22, v20, v20, vcc row_ror:8 row_mask:0xf bank_mask:0xf
    v_add_f32 v18, v12, v13
    v_add_f32 v19, v14, v15
    v_cvt_pk_bf16_f32 v12, v12, v12
    v_cvt_pk_bf16_f32 v13, v13, v13
    v_cvt_pk_bf16_f32 v14, v14, v14
    v_cvt_pk_bf16_f32 v15, v15, v15
    v_add_f32 v18, v18, v19
    v_fma_f32 v17, v17, v20, v18
    v_and_b32 v24, v12, v4
    v_and_b32 v25, v12, v5
    v_and_b32 v26, v12, v6
    v_and_b32 v27, v12, v7
    v_and_b32 v28, v13, v4
    v_and_b32 v29, v13, v5
    v_and_b32 v30, v13, v6
    v_and_b32 v31, v13, v7
    v_and_b32 v32, v14, v4
    v_and_b32 v33, v14, v5
    v_and_b32 v34, v14, v6
    v_and_b32 v35, v14, v7
    v_and_b32 v36, v15, v4
    v_and_b32 v37, v15, v5
    v_and_b32 v38, v15, v6
    v_and_b32 v39, v15, v7
    s_setprio 0
    s_nop 0
L_loop:
    s_cmp_lg_u32 s53, 0
    s_cbranch_scc1 L_noissue0
    s_waitcnt lgkmcnt(0)
    v_readfirstlane_b32 s48, v57
    s_mov_b32 s96, s52
    s_mov_b64 exec, 1
    ds_add_rtn_u32 v57, v56, v59 offset:536
    s_mov_b64 exec, -1
    s_lshl_b32 s52, s48, 12
    s_add_u32 s52, s52, s51
    s_cmp_lt_u32 s48, s49
    s_addc_u32 s54, s54, 0
    s_add_u32 m0, s56, 12288
    s_nop 0
    buffer_load_dwordx4 v60, s[4:7], s52 offen offset:0 nt lds
    buffer_load_dwordx4 v61, s[4:7], s52 offen offset:1024 nt lds
    buffer_load_dwordx4 v62, s[4:7], s52 offen offset:2048 nt lds
    buffer_load_dwordx4 v63, s[4:7], s52 offen offset:3072 nt lds
    buffer_load_dwordx4 v[160:163], v2, s[8:11], s96 offen offset:0 nt
    buffer_load_dwordx4 v[164:167], v2, s[8:11], s96 offen offset:1024 nt
    buffer_load_dwordx4 v[168:171], v2, s[8:11], s96 offen offset:2048 nt
    buffer_load_dwordx4 v[172:175], v2, s[8:11], s96 offen offset:3072 nt
    s_add_u32 s53, s53, 1
L_noissue0:
    s_sub_u32 s53, s53, 1
    v_mul_f32 v8, v22, v8
    v_mul_f32 v9, v22, v9
    v_mul_f32 v10, v22, v10
    v_mul_f32 v11, v22, v11
    s_cmp_eq_u32 s54, 1
    s_cbranch_scc1 L_last0
    s_waitcnt vmcnt(20)
    s_setprio 3
    ds_read_b128 v[64:67], v80 offset:4096
    ds_read_b128 v[68:71], v81 offset:4096
    ds_read_b128 v[72:75], v82 offset:4096
    ds_read_b128 v[76:79], v83 offset:4096
    s_waitcnt lgkmcnt(3)
    v_mfma_f32_16x16x32_bf16 v[12:15], v[64:67], v[40:43], 0
    s_waitcnt lgkmcnt(2)
    v_mfma_f32_16x16x32_bf16 v[12:15], v[68:71], v[44:47], v[12:15]
    s_waitcnt lgkmcnt(1)
    v_mfma_f32_16x16x32_bf16 v[12:15], v[72:75], v[48:51], v[12:15]
    s_waitcnt lgkmcnt(0)
    v_mfma_f32_16x16x32_bf16 v[12:15], v[76:79], v[52:55], v[12:15]
    s_nop 7
    v_cvt_pk_bf16_f32 v12, 0, v12
    v_cvt_pk_bf16_f32 v13, 0, v13
    v_cvt_pk_bf16_f32 v14, 0, v14
    v_cvt_pk_bf16_f32 v15, 0, v15
    v_mul_f32 v12, s63, v12
    v_mul_f32 v13, s63, v13
    v_mul_f32 v14, s63, v14
    v_mul_f32 v15, s63, v15
    v_cvt_pk_bf16_f32 v12, 0, v12
    v_cvt_pk_bf16_f32 v13, 0, v13
    v_cvt_pk_bf16_f32 v14, 0, v14
    v_cvt_pk_bf16_f32 v15, 0, v15
    v_max3_f32 v18, v12, v13, v14
    v_max3_f32 v18, v18, v15, v16
    v_mov_b32 v19, v18
    s_nop 1
    v_permlane32_swap_b32 v18, v19
    v_max_f32 v18, v18, v19
    v_mov_b32 v19, v18
    s_nop 1
    v_permlane16_swap_b32 v18, v19
    v_max_f32 v18, v18, v19
    v_sub_f32 v20, v16, v18
    v_mul_f32 v21, s62, v18
    v_mul_f32 v20, s62, v20
    v_mov_b32 v16, v18
    v_exp_f32 v20, v20
    v_fma_f32 v12, v12, s62, -v21
    v_fma_f32 v13, v13, s62, -v21
    v_fma_f32 v14, v14, s62, -v21
    v_fma_f32 v15, v15, s62, -v21
    v_exp_f32 v12, v12
    v_exp_f32 v13, v13
    v_exp_f32 v14, v14
    v_exp_f32 v15, v15
    v_cndmask_b32_dpp v23, v20, v20, vcc row_ror:8 row_mask:0xf bank_mask:0xf
    v_add_f32 v18, v12, v13
    v_add_f32 v19, v14, v15
    v_cvt_pk_bf16_f32 v12, v12, v12
    v_cvt_pk_bf16_f32 v13, v13, v13
    v_cvt_pk_bf16_f32 v14, v14, v14
    v_cvt_pk_bf16_f32 v15, v15, v15
    v_add_f32 v18, v18, v19
    v_fma_f32 v17, v17, v20, v18
    v_and_b32 v96, v12, v4
    v_and_b32 v97, v12, v5
    v_and_b32 v98, v12, v6
    v_and_b32 v99, v12, v7
    v_and_b32 v100, v13, v4
    v_and_b32 v101, v13, v5
    v_and_b32 v102, v13, v6
    v_and_b32 v103, v13, v7
    v_and_b32 v104, v14, v4
    v_and_b32 v105, v14, v5
    v_and_b32 v106, v14, v6
    v_and_b32 v107, v14, v7
    v_and_b32 v108, v15, v4
    v_and_b32 v109, v15, v5
    v_and_b32 v110, v15, v6
    v_and_b32 v111, v15, v7
    s_sub_u32 s54, s54, 1
    s_waitcnt vmcnt(16)
    v_mfma_f32_16x16x32_bf16 v[8:11], v[24:27], v[128:131], v[8:11]
    v_mfma_f32_16x16x32_bf16 v[8:11], v[28:31], v[132:135], v[8:11]
    v_mfma_f32_16x16x32_bf16 v[8:11], v[32:35], v[136:139], v[8:11]
    v_mfma_f32_16x16x32_bf16 v[8:11], v[36:39], v[140:143], v[8:11]
    s_setprio 0
    s_cmp_lg_u32 s53, 0
    s_nop 4
    s_cbranch_scc1 L_noissue1
    s_waitcnt lgkmcnt(0)
    v_readfirstlane_b32 s48, v57
    s_mov_b32 s96, s52
    s_mov_b64 exec, 1
    ds_add_rtn_u32 v57, v56, v59 offset:536
    s_mov_b64 exec, -1
    s_lshl_b32 s52, s48, 12
    s_add_u32 s52, s52, s51
    s_cmp_lt_u32 s48, s49
    s_addc_u32 s54, s54, 0
    s_add_u32 m0, s56, 16384
    s_nop 0
    buffer_load_dwordx4 v60, s[4:7], s52 offen offset:0 nt lds
    buffer_load_dwordx4 v61, s[4:7], s52 offen offset:1024 nt lds
    buffer_load_dwordx4 v62, s[4:7], s52 offen offset:2048 nt lds
    buffer_load_dwordx4 v63, s[4:7], s52 offen offset:3072 nt lds
    buffer_load_dwordx4 v[176:179], v2, s[8:11], s96 offen offset:0 nt
    buffer_load_dwordx4 v[180:183], v2, s[8:11], s96 offen offset:1024 nt
    buffer_load_dwordx4 v[184:187], v2, s[8:11], s96 offen offset:2048 nt
    buffer_load_dwordx4 v[188:191], v2, s[8:11], s96 offen offset:3072 nt
    s_add_u32 s53, s53, 1
L_noissue1:
    s_sub_u32 s53, s53, 1
    v_mul_f32 v8, v23, v8
    v_mul_f32 v9, v23, v9
    v_mul_f32 v10, v23, v10
    v_mul_f32 v11, v23, v11
    s_cmp_eq_u32 s54, 1
    s_cbranch_scc1 L_last1
    s_waitcnt vmcnt(20)
    s_setprio 3
    ds_read_b128 v[64:67], v80 offset:8192
    ds_read_b128 v[68:71], v81 offset:8192
    ds_read_b128 v[72:75], v82 offset:8192
    ds_read_b128 v[76:79], v83 offset:8192
    s_waitcnt lgkmcnt(3)
    v_mfma_f32_16x16x32_bf16 v[12:15], v[64:67], v[40:43], 0
    s_waitcnt lgkmcnt(2)
    v_mfma_f32_16x16x32_bf16 v[12:15], v[68:71], v[44:47], v[12:15]
    s_waitcnt lgkmcnt(1)
    v_mfma_f32_16x16x32_bf16 v[12:15], v[72:75], v[48:51], v[12:15]
    s_waitcnt lgkmcnt(0)
    v_mfma_f32_16x16x32_bf16 v[12:15], v[76:79], v[52:55], v[12:15]
    s_nop 7
    v_cvt_pk_bf16_f32 v12, 0, v12
    v_cvt_pk_bf16_f32 v13, 0, v13
    v_cvt_pk_bf16_f32 v14, 0, v14
    v_cvt_pk_bf16_f32 v15, 0, v15
    v_mul_f32 v12, s63, v12
    v_mul_f32 v13, s63, v13
    v_mul_f32 v14, s63, v14
    v_mul_f32 v15, s63, v15
    v_cvt_pk_bf16_f32 v12, 0, v12
    v_cvt_pk_bf16_f32 v13, 0, v13
    v_cvt_pk_bf16_f32 v14, 0, v14
    v_cvt_pk_bf16_f32 v15, 0, v15
    v_max3_f32 v18, v12, v13, v14
    v_max3_f32 v18, v18, v15, v16
    v_mov_b32 v19, v18
    s_nop 1
    v_permlane32_swap_b32 v18, v19
    v_max_f32 v18, v18, v19
    v_mov_b32 v19, v18
    s_nop 1
    v_permlane16_swap_b32 v18, v19
    v_max_f32 v18, v18, v19
    v_sub_f32 v20, v16, v18
    v_mul_f32 v21, s62, v18
    v_mul_f32 v20, s62, v20
    v_mov_b32 v16, v18
    v_exp_f32 v20, v20
    v_fma_f32 v12, v12, s62, -v21
    v_fma_f32 v13, v13, s62, -v21
    v_fma_f32 v14, v14, s62, -v21
    v_fma_f32 v15, v15, s62, -v21
    v_exp_f32 v12, v12
    v_exp_f32 v13, v13
    v_exp_f32 v14, v14
    v_exp_f32 v15, v15
    v_cndmask_b32_dpp v22, v20, v20, vcc row_ror:8 row_mask:0xf bank_mask:0xf
    v_add_f32 v18, v12, v13
    v_add_f32 v19, v14, v15
    v_cvt_pk_bf16_f32 v12, v12, v12
    v_cvt_pk_bf16_f32 v13, v13, v13
    v_cvt_pk_bf16_f32 v14, v14, v14
    v_cvt_pk_bf16_f32 v15, v15, v15
    v_add_f32 v18, v18, v19
    v_fma_f32 v17, v17, v20, v18
    v_and_b32 v24, v12, v4
    v_and_b32 v25, v12, v5
    v_and_b32 v26, v12, v6
    v_and_b32 v27, v12, v7
    v_and_b32 v28, v13, v4
    v_and_b32 v29, v13, v5
    v_and_b32 v30, v13, v6
    v_and_b32 v31, v13, v7
    v_and_b32 v32, v14, v4
    v_and_b32 v33, v14, v5
    v_and_b32 v34, v14, v6
    v_and_b32 v35, v14, v7
    v_and_b32 v36, v15, v4
    v_and_b32 v37, v15, v5
    v_and_b32 v38, v15, v6
    v_and_b32 v39, v15, v7
    s_sub_u32 s54, s54, 1
    s_waitcnt vmcnt(16)
    v_mfma_f32_16x16x32_bf16 v[8:11], v[96:99], v[144:147], v[8:11]
    v_mfma_f32_16x16x32_bf16 v[8:11], v[100:103], v[148:151], v[8:11]
    v_mfma_f32_16x16x32_bf16 v[8:11], v[104:107], v[152:155], v[8:11]
    v_mfma_f32_16x16x32_bf16 v[8:11], v[108:111], v[156:159], v[8:11]
    s_setprio 0
    s_cmp_lg_u32 s53, 0
    s_nop 4
    s_cbranch_scc1 L_noissue2
    s_waitcnt lgkmcnt(0)
    v_readfirstlane_b32 s48, v57
    s_mov_b32 s96, s52
    s_mov_b64 exec, 1
    ds_add_rtn_u32 v57, v56, v59 offset:536
    s_mov_b64 exec, -1
    s_lshl_b32 s52, s48, 12
    s_add_u32 s52, s52, s51
    s_cmp_lt_u32 s48, s49
    s_addc_u32 s54, s54, 0
    s_add_u32 m0, s56, 20480
    s_nop 0
    buffer_load_dwordx4 v60, s[4:7], s52 offen offset:0 nt lds
    buffer_load_dwordx4 v61, s[4:7], s52 offen offset:1024 nt lds
    buffer_load_dwordx4 v62, s[4:7], s52 offen offset:2048 nt lds
    buffer_load_dwordx4 v63, s[4:7], s52 offen offset:3072 nt lds
    buffer_load_dwordx4 v[192:195], v2, s[8:11], s96 offen offset:0 nt
    buffer_load_dwordx4 v[196:199], v2, s[8:11], s96 offen offset:1024 nt
    buffer_load_dwordx4 v[200:203], v2, s[8:11], s96 offen offset:2048 nt
    buffer_load_dwordx4 v[204:207], v2, s[8:11], s96 offen offset:3072 nt
    s_add_u32 s53, s53, 1
L_noissue2:
    s_sub_u32 s53, s53, 1
    v_mul_f32 v8, v22, v8
    v_mul_f32 v9, v22, v9
    v_mul_f32 v10, v22, v10
    v_mul_f32 v11, v22, v11
    s_cmp_eq_u32 s54, 1
    s_cbranch_scc1 L_last2
    s_waitcnt vmcnt(20)
    s_setprio 3
    ds_read_b128 v[64:67], v80 offset:12288
    ds_read_b128 v[68:71], v81 offset:12288
    ds_read_b128 v[72:75], v82 offset:12288
    ds_read_b128 v[76:79], v83 offset:12288
    s_waitcnt lgkmcnt(3)
    v_mfma_f32_16x16x32_bf16 v[12:15], v[64:67], v[40:43], 0
    s_waitcnt lgkmcnt(2)
    v_mfma_f32_16x16x32_bf16 v[12:15], v[68:71], v[44:47], v[12:15]
    s_waitcnt lgkmcnt(1)
    v_mfma_f32_16x16x32_bf16 v[12:15], v[72:75], v[48:51], v[12:15]
    s_waitcnt lgkmcnt(0)
    v_mfma_f32_16x16x32_bf16 v[12:15], v[76:79], v[52:55], v[12:15]
    s_nop 7
    v_cvt_pk_bf16_f32 v12, 0, v12
    v_cvt_pk_bf16_f32 v13, 0, v13
    v_cvt_pk_bf16_f32 v14, 0, v14
    v_cvt_pk_bf16_f32 v15, 0, v15
    v_mul_f32 v12, s63, v12
    v_mul_f32 v13, s63, v13
    v_mul_f32 v14, s63, v14
    v_mul_f32 v15, s63, v15
    v_cvt_pk_bf16_f32 v12, 0, v12
    v_cvt_pk_bf16_f32 v13, 0, v13
    v_cvt_pk_bf16_f32 v14, 0, v14
    v_cvt_pk_bf16_f32 v15, 0, v15
    v_max3_f32 v18, v12, v13, v14
    v_max3_f32 v18, v18, v15, v16
    v_mov_b32 v19, v18
    s_nop 1
    v_permlane32_swap_b32 v18, v19
    v_max_f32 v18, v18, v19
    v_mov_b32 v19, v18
    s_nop 1
    v_permlane16_swap_b32 v18, v19
    v_max_f32 v18, v18, v19
    v_sub_f32 v20, v16, v18
    v_mul_f32 v21, s62, v18
    v_mul_f32 v20, s62, v20
    v_mov_b32 v16, v18
    v_exp_f32 v20, v20
    v_fma_f32 v12, v12, s62, -v21
    v_fma_f32 v13, v13, s62, -v21
    v_fma_f32 v14, v14, s62, -v21
    v_fma_f32 v15, v15, s62, -v21
    v_exp_f32 v12, v12
    v_exp_f32 v13, v13
    v_exp_f32 v14, v14
    v_exp_f32 v15, v15
    v_cndmask_b32_dpp v23, v20, v20, vcc row_ror:8 row_mask:0xf bank_mask:0xf
    v_add_f32 v18, v12, v13
    v_add_f32 v19, v14, v15
    v_cvt_pk_bf16_f32 v12, v12, v12
    v_cvt_pk_bf16_f32 v13, v13, v13
    v_cvt_pk_bf16_f32 v14, v14, v14
    v_cvt_pk_bf16_f32 v15, v15, v15
    v_add_f32 v18, v18, v19
    v_fma_f32 v17, v17, v20, v18
    v_and_b32 v96, v12, v4
    v_and_b32 v97, v12, v5
    v_and_b32 v98, v12, v6
    v_and_b32 v99, v12, v7
    v_and_b32 v100, v13, v4
    v_and_b32 v101, v13, v5
    v_and_b32 v102, v13, v6
    v_and_b32 v103, v13, v7
    v_and_b32 v104, v14, v4
    v_and_b32 v105, v14, v5
    v_and_b32 v106, v14, v6
    v_and_b32 v107, v14, v7
    v_and_b32 v108, v15, v4
    v_and_b32 v109, v15, v5
    v_and_b32 v110, v15, v6
    v_and_b32 v111, v15, v7
    s_sub_u32 s54, s54, 1
    s_waitcnt vmcnt(16)
    v_mfma_f32_16x16x32_bf16 v[8:11], v[24:27], v[160:163], v[8:11]
    v_mfma_f32_16x16x32_bf16 v[8:11], v[28:31], v[164:167], v[8:11]
    v_mfma_f32_16x16x32_bf16 v[8:11], v[32:35], v[168:171], v[8:11]
    v_mfma_f32_16x16x32_bf16 v[8:11], v[36:39], v[172:175], v[8:11]
    s_setprio 0
    s_cmp_lg_u32 s53, 0
    s_nop 4
    s_cbranch_scc1 L_noissue3
    s_waitcnt lgkmcnt(0)
    v_readfirstlane_b32 s48, v57
    s_mov_b32 s96, s52
    s_mov_b64 exec, 1
    ds_add_rtn_u32 v57, v56, v59 offset:536
    s_mov_b64 exec, -1
    s_lshl_b32 s52, s48, 12
    s_add_u32 s52, s52, s51
    s_cmp_lt_u32 s48, s49
    s_addc_u32 s54, s54, 0
    s_add_u32 m0, s56, 24576
    s_nop 0
    buffer_load_dwordx4 v60, s[4:7], s52 offen offset:0 nt lds
    buffer_load_dwordx4 v61, s[4:7], s52 offen offset:1024 nt lds
    buffer_load_dwordx4 v62, s[4:7], s52 offen offset:2048 nt lds
    buffer_load_dwordx4 v63, s[4:7], s52 offen offset:3072 nt lds
    buffer_load_dwordx4 v[208:211], v2, s[8:11], s96 offen offset:0 nt
    buffer_load_dwordx4 v[212:215], v2, s[8:11], s96 offen offset:1024 nt
    buffer_load_dwordx4 v[216:219], v2, s[8:11], s96 offen offset:2048 nt
    buffer_load_dwordx4 v[220:223], v2, s[8:11], s96 offen offset:3072 nt
    s_add_u32 s53, s53, 1
L_noissue3:
    s_sub_u32 s53, s53, 1
    v_mul_f32 v8, v23, v8
    v_mul_f32 v9, v23, v9
    v_mul_f32 v10, v23, v10
    v_mul_f32 v11, v23, v11
    s_cmp_eq_u32 s54, 1
    s_cbranch_scc1 L_last3
    s_waitcnt vmcnt(20)
    s_setprio 3
    ds_read_b128 v[64:67], v80 offset:16384
    ds_read_b128 v[68:71], v81 offset:16384
    ds_read_b128 v[72:75], v82 offset:16384
    ds_read_b128 v[76:79], v83 offset:16384
    s_waitcnt lgkmcnt(3)
    v_mfma_f32_16x16x32_bf16 v[12:15], v[64:67], v[40:43], 0
    s_waitcnt lgkmcnt(2)
    v_mfma_f32_16x16x32_bf16 v[12:15], v[68:71], v[44:47], v[12:15]
    s_waitcnt lgkmcnt(1)
    v_mfma_f32_16x16x32_bf16 v[12:15], v[72:75], v[48:51], v[12:15]
    s_waitcnt lgkmcnt(0)
    v_mfma_f32_16x16x32_bf16 v[12:15], v[76:79], v[52:55], v[12:15]
    s_nop 7
    v_cvt_pk_bf16_f32 v12, 0, v12
    v_cvt_pk_bf16_f32 v13, 0, v13
    v_cvt_pk_bf16_f32 v14, 0, v14
    v_cvt_pk_bf16_f32 v15, 0, v15
    v_mul_f32 v12, s63, v12
    v_mul_f32 v13, s63, v13
    v_mul_f32 v14, s63, v14
    v_mul_f32 v15, s63, v15
    v_cvt_pk_bf16_f32 v12, 0, v12
    v_cvt_pk_bf16_f32 v13, 0, v13
    v_cvt_pk_bf16_f32 v14, 0, v14
    v_cvt_pk_bf16_f32 v15, 0, v15
    v_max3_f32 v18, v12, v13, v14
    v_max3_f32 v18, v18, v15, v16
    v_mov_b32 v19, v18
    s_nop 1
    v_permlane32_swap_b32 v18, v19
    v_max_f32 v18, v18, v19
    v_mov_b32 v19, v18
    s_nop 1
    v_permlane16_swap_b32 v18, v19
    v_max_f32 v18, v18, v19
    v_sub_f32 v20, v16, v18
    v_mul_f32 v21, s62, v18
    v_mul_f32 v20, s62, v20
    v_mov_b32 v16, v18
    v_exp_f32 v20, v20
    v_fma_f32 v12, v12, s62, -v21
    v_fma_f32 v13, v13, s62, -v21
    v_fma_f32 v14, v14, s62, -v21
    v_fma_f32 v15, v15, s62, -v21
    v_exp_f32 v12, v12
    v_exp_f32 v13, v13
    v_exp_f32 v14, v14
    v_exp_f32 v15, v15
    v_cndmask_b32_dpp v22, v20, v20, vcc row_ror:8 row_mask:0xf bank_mask:0xf
    v_add_f32 v18, v12, v13
    v_add_f32 v19, v14, v15
    v_cvt_pk_bf16_f32 v12, v12, v12
    v_cvt_pk_bf16_f32 v13, v13, v13
    v_cvt_pk_bf16_f32 v14, v14, v14
    v_cvt_pk_bf16_f32 v15, v15, v15
    v_add_f32 v18, v18, v19
    v_fma_f32 v17, v17, v20, v18
    v_and_b32 v24, v12, v4
    v_and_b32 v25, v12, v5
    v_and_b32 v26, v12, v6
    v_and_b32 v27, v12, v7
    v_and_b32 v28, v13, v4
    v_and_b32 v29, v13, v5
    v_and_b32 v30, v13, v6
    v_and_b32 v31, v13, v7
    v_and_b32 v32, v14, v4
    v_and_b32 v33, v14, v5
    v_and_b32 v34, v14, v6
    v_and_b32 v35, v14, v7
    v_and_b32 v36, v15, v4
    v_and_b32 v37, v15, v5
    v_and_b32 v38, v15, v6
    v_and_b32 v39, v15, v7
    s_sub_u32 s54, s54, 1
    s_waitcnt vmcnt(16)
    v_mfma_f32_16x16x32_bf16 v[8:11], v[96:99], v[176:179], v[8:11]
    v_mfma_f32_16x16x32_bf16 v[8:11], v[100:103], v[180:183], v[8:11]
    v_mfma_f32_16x16x32_bf16 v[8:11], v[104:107], v[184:187], v[8:11]
    v_mfma_f32_16x16x32_bf16 v[8:11], v[108:111], v[188:191], v[8:11]
    s_setprio 0
    s_cmp_lg_u32 s53, 0
    s_nop 4
    s_cbranch_scc1 L_noissue4
    s_waitcnt lgkmcnt(0)
    v_readfirstlane_b32 s48, v57
    s_mov_b32 s96, s52
    s_mov_b64 exec, 1
    ds_add_rtn_u32 v57, v56, v59 offset:536
    s_mov_b64 exec, -1
    s_lshl_b32 s52, s48, 12
    s_add_u32 s52, s52, s51
    s_cmp_lt_u32 s48, s49
    s_addc_u32 s54, s54, 0
    s_add_u32 m0, s56, 28672
    s_nop 0
    buffer_load_dwordx4 v60, s[4:7], s52 offen offset:0 nt lds
    buffer_load_dwordx4 v61, s[4:7], s52 offen offset:1024 nt lds
    buffer_load_dwordx4 v62, s[4:7], s52 offen offset:2048 nt lds
    buffer_load_dwordx4 v63, s[4:7], s52 offen offset:3072 nt lds
    buffer_load_dwordx4 v[224:227], v2, s[8:11], s96 offen offset:0 nt
    buffer_load_dwordx4 v[228:231], v2, s[8:11], s96 offen offset:1024 nt
    buffer_load_dwordx4 v[232:235], v2, s[8:11], s96 offen offset:2048 nt
    buffer_load_dwordx4 v[236:239], v2, s[8:11], s96 offen offset:3072 nt
    s_add_u32 s53, s53, 1
L_noissue4:
    s_sub_u32 s53, s53, 1
    v_mul_f32 v8, v22, v8
    v_mul_f32 v9, v22, v9
    v_mul_f32 v10, v22, v10
    v_mul_f32 v11, v22, v11
    s_cmp_eq_u32 s54, 1
    s_cbranch_scc1 L_last4
    s_waitcnt vmcnt(20)
    s_setprio 3
    ds_read_b128 v[64:67], v80 offset:20480
    ds_read_b128 v[68:71], v81 offset:20480
    ds_read_b128 v[72:75], v82 offset:20480
    ds_read_b128 v[76:79], v83 offset:20480
    s_waitcnt lgkmcnt(3)
    v_mfma_f32_16x16x32_bf16 v[12:15], v[64:67], v[40:43], 0
    s_waitcnt lgkmcnt(2)
    v_mfma_f32_16x16x32_bf16 v[12:15], v[68:71], v[44:47], v[12:15]
    s_waitcnt lgkmcnt(1)
    v_mfma_f32_16x16x32_bf16 v[12:15], v[72:75], v[48:51], v[12:15]
    s_waitcnt lgkmcnt(0)
    v_mfma_f32_16x16x32_bf16 v[12:15], v[76:79], v[52:55], v[12:15]
    s_nop 7
    v_cvt_pk_bf16_f32 v12, 0, v12
    v_cvt_pk_bf16_f32 v13, 0, v13
    v_cvt_pk_bf16_f32 v14, 0, v14
    v_cvt_pk_bf16_f32 v15, 0, v15
    v_mul_f32 v12, s63, v12
    v_mul_f32 v13, s63, v13
    v_mul_f32 v14, s63, v14
    v_mul_f32 v15, s63, v15
    v_cvt_pk_bf16_f32 v12, 0, v12
    v_cvt_pk_bf16_f32 v13, 0, v13
    v_cvt_pk_bf16_f32 v14, 0, v14
    v_cvt_pk_bf16_f32 v15, 0, v15
    v_max3_f32 v18, v12, v13, v14
    v_max3_f32 v18, v18, v15, v16
    v_mov_b32 v19, v18
    s_nop 1
    v_permlane32_swap_b32 v18, v19
    v_max_f32 v18, v18, v19
    v_mov_b32 v19, v18
    s_nop 1
    v_permlane16_swap_b32 v18, v19
    v_max_f32 v18, v18, v19
    v_sub_f32 v20, v16, v18
    v_mul_f32 v21, s62, v18
    v_mul_f32 v20, s62, v20
    v_mov_b32 v16, v18
    v_exp_f32 v20, v20
    v_fma_f32 v12, v12, s62, -v21
    v_fma_f32 v13, v13, s62, -v21
    v_fma_f32 v14, v14, s62, -v21
    v_fma_f32 v15, v15, s62, -v21
    v_exp_f32 v12, v12
    v_exp_f32 v13, v13
    v_exp_f32 v14, v14
    v_exp_f32 v15, v15
    v_cndmask_b32_dpp v23, v20, v20, vcc row_ror:8 row_mask:0xf bank_mask:0xf
    v_add_f32 v18, v12, v13
    v_add_f32 v19, v14, v15
    v_cvt_pk_bf16_f32 v12, v12, v12
    v_cvt_pk_bf16_f32 v13, v13, v13
    v_cvt_pk_bf16_f32 v14, v14, v14
    v_cvt_pk_bf16_f32 v15, v15, v15
    v_add_f32 v18, v18, v19
    v_fma_f32 v17, v17, v20, v18
    v_and_b32 v96, v12, v4
    v_and_b32 v97, v12, v5
    v_and_b32 v98, v12, v6
    v_and_b32 v99, v12, v7
    v_and_b32 v100, v13, v4
    v_and_b32 v101, v13, v5
    v_and_b32 v102, v13, v6
    v_and_b32 v103, v13, v7
    v_and_b32 v104, v14, v4
    v_and_b32 v105, v14, v5
    v_and_b32 v106, v14, v6
    v_and_b32 v107, v14, v7
    v_and_b32 v108, v15, v4
    v_and_b32 v109, v15, v5
    v_and_b32 v110, v15, v6
    v_and_b32 v111, v15, v7
    s_sub_u32 s54, s54, 1
    s_waitcnt vmcnt(16)
    v_mfma_f32_16x16x32_bf16 v[8:11], v[24:27], v[192:195], v[8:11]
    v_mfma_f32_16x16x32_bf16 v[8:11], v[28:31], v[196:199], v[8:11]
    v_mfma_f32_16x16x32_bf16 v[8:11], v[32:35], v[200:203], v[8:11]
    v_mfma_f32_16x16x32_bf16 v[8:11], v[36:39], v[204:207], v[8:11]
    s_setprio 0
    s_waitcnt lgkmcnt(0)
    v_readfirstlane_b32 s48, v57
    s_mov_b32 s96, s52
    s_mov_b64 exec, 1
    ds_add_rtn_u32 v57, v56, v59 offset:536
    s_mov_b64 exec, -1
    s_lshl_b32 s52, s48, 12
    s_add_u32 s52, s52, s51
    s_cmp_lt_u32 s48, s49
    s_addc_u32 s54, s54, 0
    s_add_u32 m0, s56, 0
    s_nop 0
    buffer_load_dwordx4 v60, s[4:7], s52 offen offset:0 nt lds
    buffer_load_dwordx4 v61, s[4:7], s52 offen offset:1024 nt lds
    buffer_load_dwordx4 v62, s[4:7], s52 offen offset:2048 nt lds
    buffer_load_dwordx4 v63, s[4:7], s52 offen offset:3072 nt lds
    buffer_load_dwordx4 v[240:243], v2, s[8:11], s96 offen offset:0 nt
    buffer_load_dwordx4 v[244:247], v2, s[8:11], s96 offen offset:1024 nt
    buffer_load_dwordx4 v[248:251], v2, s[8:11], s96 offen offset:2048 nt
    buffer_load_dwordx4 v[252:255], v2, s[8:11], s96 offen offset:3072 nt
    v_mul_f32 v8, v23, v8
    v_mul_f32 v9, v23, v9
    v_mul_f32 v10, v23, v10
    v_mul_f32 v11, v23, v11
    s_cmp_eq_u32 s54, 1
    s_cbranch_scc1 L_last5
    s_waitcnt vmcnt(20)
    s_setprio 3
    ds_read_b128 v[64:67], v80 offset:24576
    ds_read_b128 v[68:71], v81 offset:24576
    ds_read_b128 v[72:75], v82 offset:24576
    ds_read_b128 v[76:79], v83 offset:24576
    s_waitcnt lgkmcnt(3)
    v_mfma_f32_16x16x32_bf16 v[12:15], v[64:67], v[40:43], 0
    s_waitcnt lgkmcnt(2)
    v_mfma_f32_16x16x32_bf16 v[12:15], v[68:71], v[44:47], v[12:15]
    s_waitcnt lgkmcnt(1)
    v_mfma_f32_16x16x32_bf16 v[12:15], v[72:75], v[48:51], v[12:15]
    s_waitcnt lgkmcnt(0)
    v_mfma_f32_16x16x32_bf16 v[12:15], v[76:79], v[52:55], v[12:15]
    s_nop 7
    v_cvt_pk_bf16_f32 v12, 0, v12
    v_cvt_pk_bf16_f32 v13, 0, v13
    v_cvt_pk_bf16_f32 v14, 0, v14
    v_cvt_pk_bf16_f32 v15, 0, v15
    v_mul_f32 v12, s63, v12
    v_mul_f32 v13, s63, v13
    v_mul_f32 v14, s63, v14
    v_mul_f32 v15, s63, v15
    v_cvt_pk_bf16_f32 v12, 0, v12
    v_cvt_pk_bf16_f32 v13, 0, v13
    v_cvt_pk_bf16_f32 v14, 0, v14
    v_cvt_pk_bf16_f32 v15, 0, v15
    v_max3_f32 v18, v12, v13, v14
    v_max3_f32 v18, v18, v15, v16
    v_mov_b32 v19, v18
    s_nop 1
    v_permlane32_swap_b32 v18, v19
    v_max_f32 v18, v18, v19
    v_mov_b32 v19, v18
    s_nop 1
    v_permlane16_swap_b32 v18, v19
    v_max_f32 v18, v18, v19
    v_sub_f32 v20, v16, v18
    v_mul_f32 v21, s62, v18
    v_mul_f32 v20, s62, v20
    v_mov_b32 v16, v18
    v_exp_f32 v20, v20
    v_fma_f32 v12, v12, s62, -v21
    v_fma_f32 v13, v13, s62, -v21
    v_fma_f32 v14, v14, s62, -v21
    v_fma_f32 v15, v15, s62, -v21
    v_exp_f32 v12, v12
    v_exp_f32 v13, v13
    v_exp_f32 v14, v14
    v_exp_f32 v15, v15
    v_cndmask_b32_dpp v22, v20, v20, vcc row_ror:8 row_mask:0xf bank_mask:0xf
    v_add_f32 v18, v12, v13
    v_add_f32 v19, v14, v15
    v_cvt_pk_bf16_f32 v12, v12, v12
    v_cvt_pk_bf16_f32 v13, v13, v13
    v_cvt_pk_bf16_f32 v14, v14, v14
    v_cvt_pk_bf16_f32 v15, v15, v15
    v_add_f32 v18, v18, v19
    v_fma_f32 v17, v17, v20, v18
    v_and_b32 v24, v12, v4
    v_and_b32 v25, v12, v5
    v_and_b32 v26, v12, v6
    v_and_b32 v27, v12, v7
    v_and_b32 v28, v13, v4
    v_and_b32 v29, v13, v5
    v_and_b32 v30, v13, v6
    v_and_b32 v31, v13, v7
    v_and_b32 v32, v14, v4
    v_and_b32 v33, v14, v5
    v_and_b32 v34, v14, v6
    v_and_b32 v35, v14, v7
    v_and_b32 v36, v15, v4
    v_and_b32 v37, v15, v5
    v_and_b32 v38, v15, v6
    v_and_b32 v39, v15, v7
    s_sub_u32 s54, s54, 1
    s_waitcnt vmcnt(16)
    v_mfma_f32_16x16x32_bf16 v[8:11], v[96:99], v[208:211], v[8:11]
    v_mfma_f32_16x16x32_bf16 v[8:11], v[100:103], v[212:215], v[8:11]
    v_mfma_f32_16x16x32_bf16 v[8:11], v[104:107], v[216:219], v[8:11]
    v_mfma_f32_16x16x32_bf16 v[8:11], v[108:111], v[220:223], v[8:11]
    s_setprio 0
    s_waitcnt lgkmcnt(0)
    v_readfirstlane_b32 s48, v57
    s_mov_b32 s96, s52
    s_mov_b64 exec, 1
    ds_add_rtn_u32 v57, v56, v59 offset:536
    s_mov_b64 exec, -1
    s_lshl_b32 s52, s48, 12
    s_add_u32 s52, s52, s51
    s_cmp_lt_u32 s48, s49
    s_addc_u32 s54, s54, 0
    s_add_u32 m0, s56, 4096
    s_nop 0
    buffer_load_dwordx4 v60, s[4:7], s52 offen offset:0 nt lds
    buffer_load_dwordx4 v61, s[4:7], s52 offen offset:1024 nt lds
    buffer_load_dwordx4 v62, s[4:7], s52 offen offset:2048 nt lds
    buffer_load_dwordx4 v63, s[4:7], s52 offen offset:3072 nt lds
    buffer_load_dwordx4 v[128:131], v2, s[8:11], s96 offen offset:0 nt
    buffer_load_dwordx4 v[132:135], v2, s[8:11], s96 offen offset:1024 nt
    buffer_load_dwordx4 v[136:139], v2, s[8:11], s96 offen offset:2048 nt
    buffer_load_dwordx4 v[140:143], v2, s[8:11], s96 offen offset:3072 nt
    v_mul_f32 v8, v22, v8
    v_mul_f32 v9, v22, v9
    v_mul_f32 v10, v22, v10
    v_mul_f32 v11, v22, v11
    s_cmp_eq_u32 s54, 1
    s_cbranch_scc1 L_last6
    s_waitcnt vmcnt(20)
    s_setprio 3
    ds_read_b128 v[64:67], v80 offset:28672
    ds_read_b128 v[68:71], v81 offset:28672
    ds_read_b128 v[72:75], v82 offset:28672
    ds_read_b128 v[76:79], v83 offset:28672
    s_waitcnt lgkmcnt(3)
    v_mfma_f32_16x16x32_bf16 v[12:15], v[64:67], v[40:43], 0
    s_waitcnt lgkmcnt(2)
    v_mfma_f32_16x16x32_bf16 v[12:15], v[68:71], v[44:47], v[12:15]
    s_waitcnt lgkmcnt(1)
    v_mfma_f32_16x16x32_bf16 v[12:15], v[72:75], v[48:51], v[12:15]
    s_waitcnt lgkmcnt(0)
    v_mfma_f32_16x16x32_bf16 v[12:15], v[76:79], v[52:55], v[12:15]
    s_nop 7
    v_cvt_pk_bf16_f32 v12, 0, v12
    v_cvt_pk_bf16_f32 v13, 0, v13
    v_cvt_pk_bf16_f32 v14, 0, v14
    v_cvt_pk_bf16_f32 v15, 0, v15
    v_mul_f32 v12, s63, v12
    v_mul_f32 v13, s63, v13
    v_mul_f32 v14, s63, v14
    v_mul_f32 v15, s63, v15
    v_cvt_pk_bf16_f32 v12, 0, v12
    v_cvt_pk_bf16_f32 v13, 0, v13
    v_cvt_pk_bf16_f32 v14, 0, v14
    v_cvt_pk_bf16_f32 v15, 0, v15
    v_max3_f32 v18, v12, v13, v14
    v_max3_f32 v18, v18, v15, v16
    v_mov_b32 v19, v18
    s_nop 1
    v_permlane32_swap_b32 v18, v19
    v_max_f32 v18, v18, v19
    v_mov_b32 v19, v18
    s_nop 1
    v_permlane16_swap_b32 v18, v19
    v_max_f32 v18, v18, v19
    v_sub_f32 v20, v16, v18
    v_mul_f32 v21, s62, v18
    v_mul_f32 v20, s62, v20
    v_mov_b32 v16, v18
    v_exp_f32 v20, v20
    v_fma_f32 v12, v12, s62, -v21
    v_fma_f32 v13, v13, s62, -v21
    v_fma_f32 v14, v14, s62, -v21
    v_fma_f32 v15, v15, s62, -v21
    v_exp_f32 v12, v12
    v_exp_f32 v13, v13
    v_exp_f32 v14, v14
    v_exp_f32 v15, v15
    v_cndmask_b32_dpp v23, v20, v20, vcc row_ror:8 row_mask:0xf bank_mask:0xf
    v_add_f32 v18, v12, v13
    v_add_f32 v19, v14, v15
    v_cvt_pk_bf16_f32 v12, v12, v12
    v_cvt_pk_bf16_f32 v13, v13, v13
    v_cvt_pk_bf16_f32 v14, v14, v14
    v_cvt_pk_bf16_f32 v15, v15, v15
    v_add_f32 v18, v18, v19
    v_fma_f32 v17, v17, v20, v18
    v_and_b32 v96, v12, v4
    v_and_b32 v97, v12, v5
    v_and_b32 v98, v12, v6
    v_and_b32 v99, v12, v7
    v_and_b32 v100, v13, v4
    v_and_b32 v101, v13, v5
    v_and_b32 v102, v13, v6
    v_and_b32 v103, v13, v7
    v_and_b32 v104, v14, v4
    v_and_b32 v105, v14, v5
    v_and_b32 v106, v14, v6
    v_and_b32 v107, v14, v7
    v_and_b32 v108, v15, v4
    v_and_b32 v109, v15, v5
    v_and_b32 v110, v15, v6
    v_and_b32 v111, v15, v7
    s_sub_u32 s54, s54, 1
    s_waitcnt vmcnt(16)
    v_mfma_f32_16x16x32_bf16 v[8:11], v[24:27], v[224:227], v[8:11]
    v_mfma_f32_16x16x32_bf16 v[8:11], v[28:31], v[228:231], v[8:11]
    v_mfma_f32_16x16x32_bf16 v[8:11], v[32:35], v[232:235], v[8:11]
    v_mfma_f32_16x16x32_bf16 v[8:11], v[36:39], v[236:239], v[8:11]
    s_setprio 0
    s_waitcnt lgkmcnt(0)
    v_readfirstlane_b32 s48, v57
    s_mov_b32 s96, s52
    s_mov_b64 exec, 1
    ds_add_rtn_u32 v57, v56, v59 offset:536
    s_mov_b64 exec, -1
    s_lshl_b32 s52, s48, 12
    s_add_u32 s52, s52, s51
    s_cmp_lt_u32 s48, s49
    s_addc_u32 s54, s54, 0
    s_add_u32 m0, s56, 8192
    s_nop 0
    buffer_load_dwordx4 v60, s[4:7], s52 offen offset:0 nt lds
    buffer_load_dwordx4 v61, s[4:7], s52 offen offset:1024 nt lds
    buffer_load_dwordx4 v62, s[4:7], s52 offen offset:2048 nt lds
    buffer_load_dwordx4 v63, s[4:7], s52 offen offset:3072 nt lds
    buffer_load_dwordx4 v[144:147], v2, s[8:11], s96 offen offset:0 nt
    buffer_load_dwordx4 v[148:151], v2, s[8:11], s96 offen offset:1024 nt
    buffer_load_dwordx4 v[152:155], v2, s[8:11], s96 offen offset:2048 nt
    buffer_load_dwordx4 v[156:159], v2, s[8:11], s96 offen offset:3072 nt
    v_mul_f32 v8, v23, v8
    v_mul_f32 v9, v23, v9
    v_mul_f32 v10, v23, v10
    v_mul_f32 v11, v23, v11
    s_cmp_eq_u32 s54, 1
    s_cbranch_scc1 L_last7
    s_waitcnt vmcnt(20)
    s_setprio 3
    ds_read_b128 v[64:67], v80 offset:0
    ds_read_b128 v[68:71], v81 offset:0
    ds_read_b128 v[72:75], v82 offset:0
    ds_read_b128 v[76:79], v83 offset:0
    s_waitcnt lgkmcnt(3)
    v_mfma_f32_16x16x32_bf16 v[12:15], v[64:67], v[40:43], 0
    s_waitcnt lgkmcnt(2)
    v_mfma_f32_16x16x32_bf16 v[12:15], v[68:71], v[44:47], v[12:15]
    s_waitcnt lgkmcnt(1)
    v_mfma_f32_16x16x32_bf16 v[12:15], v[72:75], v[48:51], v[12:15]
    s_waitcnt lgkmcnt(0)
    v_mfma_f32_16x16x32_bf16 v[12:15], v[76:79], v[52:55], v[12:15]
    s_nop 7
    v_cvt_pk_bf16_f32 v12, 0, v12
    v_cvt_pk_bf16_f32 v13, 0, v13
    v_cvt_pk_bf16_f32 v14, 0, v14
    v_cvt_pk_bf16_f32 v15, 0, v15
    v_mul_f32 v12, s63, v12
    v_mul_f32 v13, s63, v13
    v_mul_f32 v14, s63, v14
    v_mul_f32 v15, s63, v15
    v_cvt_pk_bf16_f32 v12, 0, v12
    v_cvt_pk_bf16_f32 v13, 0, v13
    v_cvt_pk_bf16_f32 v14, 0, v14
    v_cvt_pk_bf16_f32 v15, 0, v15
    v_max3_f32 v18, v12, v13, v14
    v_max3_f32 v18, v18, v15, v16
    v_mov_b32 v19, v18
    s_nop 1
    v_permlane32_swap_b32 v18, v19
    v_max_f32 v18, v18, v19
    v_mov_b32 v19, v18
    s_nop 1
    v_permlane16_swap_b32 v18, v19
    v_max_f32 v18, v18, v19
    v_sub_f32 v20, v16, v18
    v_mul_f32 v21, s62, v18
    v_mul_f32 v20, s62, v20
    v_mov_b32 v16, v18
    v_exp_f32 v20, v20
    v_fma_f32 v12, v12, s62, -v21
    v_fma_f32 v13, v13, s62, -v21
    v_fma_f32 v14, v14, s62, -v21
    v_fma_f32 v15, v15, s62, -v21
    v_exp_f32 v12, v12
    v_exp_f32 v13, v13
    v_exp_f32 v14, v14
    v_exp_f32 v15, v15
    v_cndmask_b32_dpp v22, v20, v20, vcc row_ror:8 row_mask:0xf bank_mask:0xf
    v_add_f32 v18, v12, v13
    v_add_f32 v19, v14, v15
    v_cvt_pk_bf16_f32 v12, v12, v12
    v_cvt_pk_bf16_f32 v13, v13, v13
    v_cvt_pk_bf16_f32 v14, v14, v14
    v_cvt_pk_bf16_f32 v15, v15, v15
    v_add_f32 v18, v18, v19
    v_fma_f32 v17, v17, v20, v18
    v_and_b32 v24, v12, v4
    v_and_b32 v25, v12, v5
    v_and_b32 v26, v12, v6
    v_and_b32 v27, v12, v7
    v_and_b32 v28, v13, v4
    v_and_b32 v29, v13, v5
    v_and_b32 v30, v13, v6
    v_and_b32 v31, v13, v7
    v_and_b32 v32, v14, v4
    v_and_b32 v33, v14, v5
    v_and_b32 v34, v14, v6
    v_and_b32 v35, v14, v7
    v_and_b32 v36, v15, v4
    v_and_b32 v37, v15, v5
    v_and_b32 v38, v15, v6
    v_and_b32 v39, v15, v7
    s_sub_u32 s54, s54, 1
    s_waitcnt vmcnt(16)
    v_mfma_f32_16x16x32_bf16 v[8:11], v[96:99], v[240:243], v[8:11]
    v_mfma_f32_16x16x32_bf16 v[8:11], v[100:103], v[244:247], v[8:11]
    v_mfma_f32_16x16x32_bf16 v[8:11], v[104:107], v[248:251], v[8:11]
    v_mfma_f32_16x16x32_bf16 v[8:11], v[108:111], v[252:255], v[8:11]
    s_setprio 0
    s_nop 5
    s_branch L_loop
L_last0:
    s_setprio 3
    v_mov_b32 v19, v17
    s_nop 1
    v_permlane32_swap_b32 v17, v19
    v_add_f32 v17, v17, v19
    v_mov_b32 v19, v17
    s_nop 1
    v_permlane16_swap_b32 v17, v19
    v_add_f32 v17, v17, v19
    v_cndmask_b32_dpp v18, v16, v16, vcc row_ror:8 row_mask:0xf bank_mask:0xf
    s_nop 0
    v_cndmask_b32_dpp v19, v17, v17, vcc row_ror:8 row_mask:0xf bank_mask:0xf
    ds_write_b64 v85, v[18:19] offset:5120
    s_waitcnt vmcnt(16)
    v_mfma_f32_16x16x32_bf16 v[8:11], v[24:27], v[128:131], v[8:11]
    v_mfma_f32_16x16x32_bf16 v[8:11], v[28:31], v[132:135], v[8:11]
    v_mfma_f32_16x16x32_bf16 v[8:11], v[32:35], v[136:139], v[8:11]
    v_mfma_f32_16x16x32_bf16 v[8:11], v[36:39], v[140:143], v[8:11]
    s_nop 6
    s_branch L_sdone
L_last1:
    s_setprio 3
    v_mov_b32 v19, v17
    s_nop 1
    v_permlane32_swap_b32 v17, v19
    v_add_f32 v17, v17, v19
    v_mov_b32 v19, v17
    s_nop 1
    v_permlane16_swap_b32 v17, v19
    v_add_f32 v17, v17, v19
    v_cndmask_b32_dpp v18, v16, v16, vcc row_ror:8 row_mask:0xf bank_mask:0xf
    s_nop 0
    v_cndmask_b32_dpp v19, v17, v17, vcc row_ror:8 row_mask:0xf bank_mask:0xf
    ds_write_b64 v85, v[18:19] offset:5120
    s_waitcnt vmcnt(16)
    v_mfma_f32_16x16x32_bf16 v[8:11], v[96:99], v[144:147], v[8:11]
    v_mfma_f32_16x16x32_bf16 v[8:11], v[100:103], v[148:151], v[8:11]
    v_mfma_f32_16x16x32_bf16 v[8:11], v[104:107], v[152:155], v[8:11]
    v_mfma_f32_16x16x32_bf16 v[8:11], v[108:111], v[156:159], v[8:11]
    s_nop 6
    s_branch L_sdone
L_last2:
    s_setprio 3
    v_mov_b32 v19, v17
    s_nop 1
    v_permlane32_swap_b32 v17, v19
    v_add_f32 v17, v17, v19
    v_mov_b32 v19, v17
    s_nop 1
    v_permlane16_swap_b32 v17, v19
    v_add_f32 v17, v17, v19
    v_cndmask_b32_dpp v18, v16, v16, vcc row_ror:8 row_mask:0xf bank_mask:0xf
    s_nop 0
    v_cndmask_b32_dpp v19, v17, v17, vcc row_ror:8 row_mask:0xf bank_mask:0xf
    ds_write_b64 v85, v[18:19] offset:5120
    s_waitcnt vmcnt(16)
    v_mfma_f32_16x16x32_bf16 v[8:11], v[24:27], v[160:163], v[8:11]
    v_mfma_f32_16x16x32_bf16 v[8:11], v[28:31], v[164:167], v[8:11]
    v_mfma_f32_16x16x32_bf16 v[8:11], v[32:35], v[168:171], v[8:11]
    v_mfma_f32_16x16x32_bf16 v[8:11], v[36:39], v[172:175], v[8:11]
    s_nop 6
    s_branch L_sdone
L_last3:
    s_setprio 3
    v_mov_b32 v19, v17
    s_nop 1
    v_permlane32_swap_b32 v17, v19
    v_add_f32 v17, v17, v19
    v_mov_b32 v19, v17
    s_nop 1
    v_permlane16_swap_b32 v17, v19
    v_add_f32 v17, v17, v19
    v_cndmask_b32_dpp v18, v16, v16, vcc row_ror:8 row_mask:0xf bank_mask:0xf
    s_nop 0
    v_cndmask_b32_dpp v19, v17, v17, vcc row_ror:8 row_mask:0xf bank_mask:0xf
    ds_write_b64 v85, v[18:19] offset:5120
    s_waitcnt vmcnt(16)
    v_mfma_f32_16x16x32_bf16 v[8:11], v[96:99], v[176:179], v[8:11]
    v_mfma_f32_16x16x32_bf16 v[8:11], v[100:103], v[180:183], v[8:11]
    v_mfma_f32_16x16x32_bf16 v[8:11], v[104:107], v[184:187], v[8:11]
    v_mfma_f32_16x16x32_bf16 v[8:11], v[108:111], v[188:191], v[8:11]
    s_nop 6
    s_branch L_sdone
L_last4:
    s_setprio 3
    v_mov_b32 v19, v17
    s_nop 1
    v_permlane32_swap_b32 v17, v19
    v_add_f32 v17, v17, v19
    v_mov_b32 v19, v17
    s_nop 1
    v_permlane16_swap_b32 v17, v19
    v_add_f32 v17, v17, v19
    v_cndmask_b32_dpp v18, v16, v16, vcc row_ror:8 row_mask:0xf bank_mask:0xf
    s_nop 0
    v_cndmask_b32_dpp v19, v17, v17, vcc row_ror:8 row_mask:0xf bank_mask:0xf
    ds_write_b64 v85, v[18:19] offset:5120
    s_waitcnt vmcnt(16)
    v_mfma_f32_16x16x32_bf16 v[8:11], v[24:27], v[192:195], v[8:11]
    v_mfma_f32_16x16x32_bf16 v[8:11], v[28:31], v[196:199], v[8:11]
    v_mfma_f32_16x16x32_bf16 v[8:11], v[32:35], v[200:203], v[8:11]
    v_mfma_f32_16x16x32_bf16 v[8:11], v[36:39], v[204:207], v[8:11]
    s_nop 6
    s_branch L_sdone
L_last5:
    s_setprio 3
    v_mov_b32 v19, v17
    s_nop 1
    v_permlane32_swap_b32 v17, v19
    v_add_f32 v17, v17, v19
    v_mov_b32 v19, v17
    s_nop 1
    v_permlane16_swap_b32 v17, v19
    v_add_f32 v17, v17, v19
    v_cndmask_b32_dpp v18, v16, v16, vcc row_ror:8 row_mask:0xf bank_mask:0xf
    s_nop 0
    v_cndmask_b32_dpp v19, v17, v17, vcc row_ror:8 row_mask:0xf bank_mask:0xf
    ds_write_b64 v85, v[18:19] offset:5120
    s_waitcnt vmcnt(16)
    v_mfma_f32_16x16x32_bf16 v[8:11], v[96:99], v[208:211], v[8:11]
    v_mfma_f32_16x16x32_bf16 v[8:11], v[100:103], v[212:215], v[8:11]
    v_mfma_f32_16x16x32_bf16 v[8:11], v[104:107], v[216:219], v[8:11]
    v_mfma_f32_16x16x32_bf16 v[8:11], v[108:111], v[220:223], v[8:11]
    s_nop 6
    s_branch L_sdone
L_last6:
    s_setprio 3
    v_mov_b32 v19, v17
    s_nop 1
    v_permlane32_swap_b32 v17, v19
    v_add_f32 v17, v17, v19
    v_mov_b32 v19, v17
    s_nop 1
    v_permlane16_swap_b32 v17, v19
    v_add_f32 v17, v17, v19
    v_cndmask_b32_dpp v18, v16, v16, vcc row_ror:8 row_mask:0xf bank_mask:0xf
    s_nop 0
    v_cndmask_b32_dpp v19, v17, v17, vcc row_ror:8 row_mask:0xf bank_mask:0xf
    ds_write_b64 v85, v[18:19] offset:5120
    s_waitcnt vmcnt(16)
    v_mfma_f32_16x16x32_bf16 v[8:11], v[24:27], v[224:227], v[8:11]
    v_mfma_f32_16x16x32_bf16 v[8:11], v[28:31], v[228:231], v[8:11]
    v_mfma_f32_16x16x32_bf16 v[8:11], v[32:35], v[232:235], v[8:11]
    v_mfma_f32_16x16x32_bf16 v[8:11], v[36:39], v[236:239], v[8:11]
    s_nop 6
    s_branch L_sdone
L_last7:
    s_setprio 3
    v_mov_b32 v19, v17
    s_nop 1
    v_permlane32_swap_b32 v17, v19
    v_add_f32 v17, v17, v19
    v_mov_b32 v19, v17
    s_nop 1
    v_permlane16_swap_b32 v17, v19
    v_add_f32 v17, v17, v19
    v_cndmask_b32_dpp v18, v16, v16, vcc row_ror:8 row_mask:0xf bank_mask:0xf
    s_nop 0
    v_cndmask_b32_dpp v19, v17, v17, vcc row_ror:8 row_mask:0xf bank_mask:0xf
    ds_write_b64 v85, v[18:19] offset:5120
    s_waitcnt vmcnt(16)
    v_mfma_f32_16x16x32_bf16 v[8:11], v[96:99], v[240:243], v[8:11]
    v_mfma_f32_16x16x32_bf16 v[8:11], v[100:103], v[244:247], v[8:11]
    v_mfma_f32_16x16x32_bf16 v[8:11], v[104:107], v[248:251], v[8:11]
    v_mfma_f32_16x16x32_bf16 v[8:11], v[108:111], v[252:255], v[8:11]
    s_nop 7
L_sdone:
    ds_write_b128 v84, v[8:11] offset:1024
    s_mov_b64 exec, 1
    ds_add_rtn_u32 v50, v56, v59 offset:528
    s_mov_b64 exec, -1
L_pub:
    ds_read_b64 v[24:25], v87 offset:5120
    ds_read_b64 v[26:27], v87 offset:5632
    ds_read_b64 v[28:29], v87 offset:6144
    ds_read_b64 v[30:31], v87 offset:6656
    ds_read_b128 v[32:35], v2 offset:1024
    ds_read_b128 v[36:39], v2 offset:2048
    ds_read_b128 v[40:43], v2 offset:3072
    ds_read_b128 v[44:47], v2 offset:4096
    s_waitcnt lgkmcnt(8)
    v_readfirstlane_b32 s48, v50
    s_nop 1
    s_cmp_eq_u32 s48, 3
    s_cselect_b32 s48, 1, s98
    s_cmp_lg_u32 s48, 0
    s_cbranch_scc0 L_after_pub
    s_waitcnt lgkmcnt(4)
    v_max_f32 v12, v24, v26
    v_max3_f32 v12, v12, v28, v30
    v_sub_f32 v24, v24, v12
    v_sub_f32 v26, v26, v12
    v_sub_f32 v28, v28, v12
    v_sub_f32 v30, v30, v12
    v_mul_f32 v24, s62, v24
    v_mul_f32 v26, s62, v26
    v_mul_f32 v28, s62, v28
    v_mul_f32 v30, s62, v30
    v_exp_f32 v24, v24
    v_exp_f32 v26, v26
    v_exp_f32 v28, v28
    v_exp_f32 v30, v30
    v_mul_f32 v13, v24, v25
    s_waitcnt lgkmcnt(0)
    v_mul_f32 v8, v24, v32
    v_mul_f32 v9, v24, v33
    v_mul_f32 v10, v24, v34
    v_mul_f32 v11, v24, v35
    v_fmac_f32 v8, v26, v36
    v_fmac_f32 v9, v26, v37
    v_fmac_f32 v10, v26, v38
    v_fmac_f32 v11, v26, v39
    v_fmac_f32 v8, v28, v40
    v_fmac_f32 v9, v28, v41
    v_fmac_f32 v10, v28, v42
    v_fmac_f32 v11, v28, v43
    v_fmac_f32 v8, v30, v44
    v_fmac_f32 v9, v30, v45
    v_fmac_f32 v10, v30, v46
    v_fmac_f32 v11, v30, v47
    v_fmac_f32 v13, v26, v27
    v_fmac_f32 v13, v28, v29
    v_fmac_f32 v13, v30, v31
    v_perm_b32 v16, v8, v11, s64
    v_perm_b32 v17, v9, v11, s65
    v_perm_b32 v18, v10, v11, s66
    v_mov_b32 v19, s47
    v_mov_b32 v14, 0
    v_mov_b32 v15, s47
    v_mov_b32 v20, 0
    v_mov_b32 v21, 1
    s_cmp_lg_u32 s98, 0
    s_cbranch_scc1 L_pub_dry_ret
    s_cmp_lg_u32 s99, 0
    s_cbranch_scc1 L_pub_far
    buffer_store_dwordx4 v[16:19], v89, s[12:15], s57 offen
    s_mov_b32 exec_lo, 1
    s_mov_b32 exec_hi, 1
    buffer_store_dwordx4 v[12:15], v88, s[12:15], s57 offen
    s_nop 0
    s_branch L_pub_end
L_pub_far:
    buffer_store_dwordx4 v[16:19], v89, s[12:15], s57 offen sc1
    s_mov_b32 exec_lo, 1
    s_mov_b32 exec_hi, 1
    buffer_store_dwordx4 v[12:15], v88, s[12:15], s57 offen sc1
    s_nop 1
L_pub_end:
    s_mov_b64 exec, -1
    ds_write_b32 v20, v21 offset:532
L_after_pub:
    s_cmp_lg_u32 s46, 0
    s_cbranch_scc1 L_final
    s_endpgm
L_pub_dry_ret:
    s_cmp_eq_u32 s98, 2
    s_cbranch_scc1 L_owner_setup
    s_endpgm
L_qphase:
    v_and_b32 v22, 1, v0
    v_cmp_eq_u32 vcc, 1, v22
    v_mov_b32 v22, 0xffff
    v_mov_b32 v23, 0xffff0000
    v_cndmask_b32 v22, v22, v23, vcc
    v_bfe_u32 v23, v0, 1, 2
    v_cmp_eq_u32 vcc, 0, v23
    s_nop 1
    v_cndmask_b32 v4, 0, v22, vcc
    v_cmp_eq_u32 vcc, 1, v23
    s_nop 1
    v_cndmask_b32 v5, 0, v22, vcc
    v_cmp_eq_u32 vcc, 2, v23
    s_nop 1
    v_cndmask_b32 v6, 0, v22, vcc
    v_cmp_eq_u32 vcc, 3, v23
    s_nop 1
    v_cndmask_b32 v7, 0, v22, vcc
    s_waitcnt vmcnt(18) lgkmcnt(0)
    v_lshlrev_b32 v168, 16, v12
    v_and_b32 v169, 0xffff0000, v12
    v_lshlrev_b32 v170, 16, v13
    v_and_b32 v171, 0xffff0000, v13
    v_lshlrev_b32 v172, 16, v14
    v_and_b32 v173, 0xffff0000, v14
    v_lshlrev_b32 v174, 16, v15
    v_and_b32 v175, 0xffff0000, v15
    v_lshlrev_b32 v176, 16, v16
    v_and_b32 v177, 0xffff0000, v16
    v_lshlrev_b32 v178, 16, v17
    v_and_b32 v179, 0xffff0000, v17
    v_lshlrev_b32 v180, 16, v18
    v_and_b32 v181, 0xffff0000, v18
    v_lshlrev_b32 v182, 16, v19
    v_and_b32 v183, 0xffff0000, v19
    v_lshlrev_b32 v184, 16, v20
    v_and_b32 v185, 0xffff0000, v20
    s_add_u32 s55, s55, 1
    s_mul_i32 s47, s55, 0x9E3779B1
    v_add_f32 v22, v168, v169
    v_add_f32 v23, v170, v171
    v_add_f32 v22, v22, v172
    v_add_f32 v23, v23, v173
    v_add_f32 v22, v22, v174
    v_add_f32 v23, v23, v175
    v_add_f32 v22, v22, v176
    v_add_f32 v23, v23, v177
    v_add_f32 v22, v22, v178
    v_add_f32 v23, v23, v179
    v_add_f32 v22, v22, v180
    v_add_f32 v23, v23, v181
    v_add_f32 v22, v22, v182
    v_add_f32 v23, v23, v183
    v_add_f32 v22, v22, v184
    v_add_f32 v23, v23, v185
    v_add_f32 v22, v22, v23
    s_nop 1
    v_add_f32_dpp v22, v22, v22 quad_perm:[1,0,3,2] row_mask:0xf bank_mask:0xf
    s_nop 1
    v_add_f32_dpp v22, v22, v22 quad_perm:[2,3,0,1] row_mask:0xf bank_mask:0xf
    s_nop 1
    v_add_f32_dpp v22, v22, v22 row_half_mirror row_mask:0xf bank_mask:0xf
    s_nop 1
    v_add_f32_dpp v22, v22, v22 row_ror:8 row_mask:0xf bank_mask:0xf
    v_mov_b32 v23, v22
    s_nop 1
    v_permlane16_swap_b32 v22, v23
    v_add_f32 v22, v22, v23
    v_mul_f32 v22, 0x3ae38e39, v22
    v_mov_b32 v24, 0
    v_mov_b32 v25, 0
    v_sub_f32 v23, v168, v22
    v_sub_f32 v26, v169, v22
    v_fmac_f32 v24, v23, v23
    v_fmac_f32 v25, v26, v26
    v_sub_f32 v23, v170, v22
    v_sub_f32 v26, v171, v22
    v_fmac_f32 v24, v23, v23
    v_fmac_f32 v25, v26, v26
    v_sub_f32 v23, v172, v22
    v_sub_f32 v26, v173, v22
    v_fmac_f32 v24, v23, v23
    v_fmac_f32 v25, v26, v26
    v_sub_f32 v23, v174, v22
    v_sub_f32 v26, v175, v22
    v_fmac_f32 v24, v23, v23
    v_fmac_f32 v25, v26, v26
    v_sub_f32 v23, v176, v22
    v_sub_f32 v26, v177, v22
    v_fmac_f32 v24, v23, v23
    v_fmac_f32 v25, v26, v26
    v_sub_f32 v23, v178, v22
    v_sub_f32 v26, v179, v22
    v_fmac_f32 v24, v23, v23
    v_fmac_f32 v25, v26, v26
    v_sub_f32 v23, v180, v22
    v_sub_f32 v26, v181, v22
    v_fmac_f32 v24, v23, v23
    v_fmac_f32 v25, v26, v26
    v_sub_f32 v23, v182, v22
    v_sub_f32 v26, v183, v22
    v_fmac_f32 v24, v23, v23
    v_fmac_f32 v25, v26, v26
    v_sub_f32 v23, v184, v22
    v_sub_f32 v26, v185, v22
    v_fmac_f32 v24, v23, v23
    v_fmac_f32 v25, v26, v26
    v_add_f32 v24, v24, v25
    s_nop 1
    v_add_f32_dpp v24, v24, v24 quad_perm:[1,0,3,2] row_mask:0xf bank_mask:0xf
    s_nop 1
    v_add_f32_dpp v24, v24, v24 quad_perm:[2,3,0,1] row_mask:0xf bank_mask:0xf
    s_nop 1
    v_add_f32_dpp v24, v24, v24 row_half_mirror row_mask:0xf bank_mask:0xf
    s_nop 1
    v_add_f32_dpp v24, v24, v24 row_ror:8 row_mask:0xf bank_mask:0xf
    v_mov_b32 v23, v24
    s_nop 1
    v_permlane16_swap_b32 v24, v23
    v_add_f32 v24, v24, v23
    v_mul_f32 v24, 0x3ae38e39, v24
    v_cvt_pk_bf16_f32 v22, 0, v22
    v_cvt_pk_bf16_f32 v24, 0, v24
    v_add_f32 v24, 0x3727c5ac, v24
    v_cvt_pk_bf16_f32 v24, 0, v24
    v_sqrt_f32 v24, v24
    v_sub_f32 v168, v168, v22
    v_sub_f32 v169, v169, v22
    v_sub_f32 v170, v170, v22
    v_sub_f32 v171, v171, v22
    v_sub_f32 v172, v172, v22
    v_sub_f32 v173, v173, v22
    v_sub_f32 v174, v174, v22
    v_sub_f32 v175, v175, v22
    v_sub_f32 v176, v176, v22
    v_sub_f32 v177, v177, v22
    v_sub_f32 v178, v178, v22
    v_sub_f32 v179, v179, v22
    v_sub_f32 v180, v180, v22
    v_sub_f32 v181, v181, v22
    v_sub_f32 v182, v182, v22
    v_sub_f32 v183, v183, v22
    v_sub_f32 v184, v184, v22
    v_sub_f32 v185, v185, v22
    v_cvt_pk_bf16_f32 v24, 0, v24
    v_rcp_f32 v24, v24
    v_cvt_pk_bf16_f32 v168, 0, v168
    v_cvt_pk_bf16_f32 v169, 0, v169
    v_cvt_pk_bf16_f32 v170, 0, v170
    v_cvt_pk_bf16_f32 v171, 0, v171
    v_cvt_pk_bf16_f32 v172, 0, v172
    v_cvt_pk_bf16_f32 v173, 0, v173
    v_cvt_pk_bf16_f32 v174, 0, v174
    v_cvt_pk_bf16_f32 v175, 0, v175
    v_cvt_pk_bf16_f32 v176, 0, v176
    v_cvt_pk_bf16_f32 v177, 0, v177
    v_cvt_pk_bf16_f32 v178, 0, v178
    v_cvt_pk_bf16_f32 v179, 0, v179
    v_cvt_pk_bf16_f32 v180, 0, v180
    v_cvt_pk_bf16_f32 v181, 0, v181
    v_cvt_pk_bf16_f32 v182, 0, v182
    v_cvt_pk_bf16_f32 v183, 0, v183
    v_cvt_pk_bf16_f32 v184, 0, v184
    v_cvt_pk_bf16_f32 v185, 0, v185
    v_mul_f32 v168, v168, v24
    v_mul_f32 v169, v169, v24
    v_mul_f32 v170, v170, v24
    v_mul_f32 v171, v171, v24
    v_mul_f32 v172, v172, v24
    v_mul_f32 v173, v173, v24
    v_mul_f32 v174, v174, v24
    v_mul_f32 v175, v175, v24
    v_mul_f32 v176, v176, v24
    v_mul_f32 v177, v177, v24
    v_mul_f32 v178, v178, v24
    v_mul_f32 v179, v179, v24
    v_mul_f32 v180, v180, v24
    v_mul_f32 v181, v181, v24
    v_mul_f32 v182, v182, v24
    v_mul_f32 v183, v183, v24
    v_mul_f32 v184, v184, v24
    v_mul_f32 v185, v185, v24
    v_cvt_pk_bf16_f32 v12, v168, v169
    v_cvt_pk_bf16_f32 v13, v170, v171
    v_cvt_pk_bf16_f32 v14, v172, v173
    v_cvt_pk_bf16_f32 v15, v174, v175
    v_cvt_pk_bf16_f32 v16, v176, v177
    v_cvt_pk_bf16_f32 v17, v178, v179
    v_cvt_pk_bf16_f32 v18, v180, v181
    v_cvt_pk_bf16_f32 v19, v182, v183
    v_cvt_pk_bf16_f32 v20, v184, v185
    v_bfe_u32 v1, v0, 3, 1
    v_lshlrev_b32 v1, 5, v1
    v_lshrrev_b32 v2, 4, v0
    v_add_u32 v1, v1, v2
    s_lshl_b32 s48, s44, 2
    v_add_lshl_u32 v1, v1, s48, 2
    ds_bpermute_b32 v24, v1, v12
    ds_bpermute_b32 v25, v1, v13
    ds_bpermute_b32 v26, v1, v14
    ds_bpermute_b32 v27, v1, v15
    ds_bpermute_b32 v28, v1, v16
    ds_bpermute_b32 v29, v1, v17
    ds_bpermute_b32 v30, v1, v18
    ds_bpermute_b32 v31, v1, v19
    ds_bpermute_b32 v32, v1, v20
    s_mov_b32 s48, 0x01000100
    s_mov_b32 s49, 0x03020302
    s_waitcnt lgkmcnt(0)
    v_perm_b32 v33, v24, v24, s48
    v_and_b32 v36, v33, v4
    v_and_b32 v37, v33, v5
    v_and_b32 v38, v33, v6
    v_and_b32 v39, v33, v7
    s_waitcnt vmcnt(17)
    s_nop 0
    v_mfma_f32_16x16x32_bf16 v[8:11], v[36:39], v[96:99], 0
    v_perm_b32 v33, v24, v24, s49
    v_and_b32 v40, v33, v4
    v_and_b32 v41, v33, v5
    v_and_b32 v42, v33, v6
    v_and_b32 v43, v33, v7
    s_waitcnt vmcnt(16)
    s_nop 0
    v_mfma_f32_16x16x32_bf16 v[8:11], v[40:43], v[100:103], v[8:11]
    v_perm_b32 v33, v25, v25, s48
    v_and_b32 v36, v33, v4
    v_and_b32 v37, v33, v5
    v_and_b32 v38, v33, v6
    v_and_b32 v39, v33, v7
    s_waitcnt vmcnt(15)
    s_nop 0
    v_mfma_f32_16x16x32_bf16 v[8:11], v[36:39], v[104:107], v[8:11]
    v_perm_b32 v33, v25, v25, s49
    v_and_b32 v40, v33, v4
    v_and_b32 v41, v33, v5
    v_and_b32 v42, v33, v6
    v_and_b32 v43, v33, v7
    s_waitcnt vmcnt(14)
    s_nop 0
    v_mfma_f32_16x16x32_bf16 v[8:11], v[40:43], v[108:111], v[8:11]
    v_perm_b32 v33, v26, v26, s48
    v_and_b32 v36, v33, v4
    v_and_b32 v37, v33, v5
    v_and_b32 v38, v33, v6
    v_and_b32 v39, v33, v7
    s_waitcnt vmcnt(13)
    s_nop 0
    v_mfma_f32_16x16x32_bf16 v[8:11], v[36:39], v[112:115], v[8:11]
    v_perm_b32 v33, v26, v26, s49
    v_and_b32 v40, v33, v4
    v_and_b32 v41, v33, v5
    v_and_b32 v42, v33, v6
    v_and_b32 v43, v33, v7
    s_waitcnt vmcnt(12)
    s_nop 0
    v_mfma_f32_16x16x32_bf16 v[8:11], v[40:43], v[116:119], v[8:11]
    v_perm_b32 v33, v27, v27, s48
    v_and_b32 v36, v33, v4
    v_and_b32 v37, v33, v5
    v_and_b32 v38, v33, v6
    v_and_b32 v39, v33, v7
    s_waitcnt vmcnt(11)
    s_nop 0
    v_mfma_f32_16x16x32_bf16 v[8:11], v[36:39], v[120:123], v[8:11]
    v_perm_b32 v33, v27, v27, s49
    v_and_b32 v40, v33, v4
    v_and_b32 v41, v33, v5
    v_and_b32 v42, v33, v6
    v_and_b32 v43, v33, v7
    s_waitcnt vmcnt(10)
    s_nop 0
    v_mfma_f32_16x16x32_bf16 v[8:11], v[40:43], v[124:127], v[8:11]
    v_perm_b32 v33, v28, v28, s48
    v_and_b32 v36, v33, v4
    v_and_b32 v37, v33, v5
    v_and_b32 v38, v33, v6
    v_and_b32 v39, v33, v7
    s_waitcnt vmcnt(9)
    s_nop 0
    v_mfma_f32_16x16x32_bf16 v[8:11], v[36:39], v[128:131], v[8:11]
    v_perm_b32 v33, v28, v28, s49
    v_and_b32 v40, v33, v4
    v_and_b32 v41, v33, v5
    v_and_b32 v42, v33, v6
    v_and_b32 v43, v33, v7
    s_waitcnt vmcnt(8)
    s_nop 0
    v_mfma_f32_16x16x32_bf16 v[8:11], v[40:43], v[132:135], v[8:11]
    v_perm_b32 v33, v29, v29, s48
    v_and_b32 v36, v33, v4
    v_and_b32 v37, v33, v5
    v_and_b32 v38, v33, v6
    v_and_b32 v39, v33, v7
    s_waitcnt vmcnt(7)
    s_nop 0
    v_mfma_f32_16x16x32_bf16 v[8:11], v[36:39], v[136:139], v[8:11]
    v_perm_b32 v33, v29, v29, s49
    v_and_b32 v40, v33, v4
    v_and_b32 v41, v33, v5
    v_and_b32 v42, v33, v6
    v_and_b32 v43, v33, v7
    s_waitcnt vmcnt(6)
    s_nop 0
    v_mfma_f32_16x16x32_bf16 v[8:11], v[40:43], v[140:143], v[8:11]
    v_perm_b32 v33, v30, v30, s48
    v_and_b32 v36, v33, v4
    v_and_b32 v37, v33, v5
    v_and_b32 v38, v33, v6
    v_and_b32 v39, v33, v7
    s_waitcnt vmcnt(5)
    s_nop 0
    v_mfma_f32_16x16x32_bf16 v[8:11], v[36:39], v[144:147], v[8:11]
    v_perm_b32 v33, v30, v30, s49
    v_and_b32 v40, v33, v4
    v_and_b32 v41, v33, v5
    v_and_b32 v42, v33, v6
    v_and_b32 v43, v33, v7
    s_waitcnt vmcnt(4)
    s_nop 0
    v_mfma_f32_16x16x32_bf16 v[8:11], v[40:43], v[148:151], v[8:11]
    v_perm_b32 v33, v31, v31, s48
    v_and_b32 v36, v33, v4
    v_and_b32 v37, v33, v5
    v_and_b32 v38, v33, v6
    v_and_b32 v39, v33, v7
    s_waitcnt vmcnt(3)
    s_nop 0
    v_mfma_f32_16x16x32_bf16 v[8:11], v[36:39], v[152:155], v[8:11]
    v_perm_b32 v33, v31, v31, s49
    v_and_b32 v40, v33, v4
    v_and_b32 v41, v33, v5
    v_and_b32 v42, v33, v6
    v_and_b32 v43, v33, v7
    s_waitcnt vmcnt(2)
    s_nop 0
    v_mfma_f32_16x16x32_bf16 v[8:11], v[40:43], v[156:159], v[8:11]
    v_perm_b32 v33, v32, v32, s48
    v_and_b32 v36, v33, v4
    v_and_b32 v37, v33, v5
    v_and_b32 v38, v33, v6
    v_and_b32 v39, v33, v7
    s_waitcnt vmcnt(1)
    s_nop 0
    v_mfma_f32_16x16x32_bf16 v[8:11], v[36:39], v[160:163], v[8:11]
    v_perm_b32 v33, v32, v32, s49
    v_and_b32 v40, v33, v4
    v_and_b32 v41, v33, v5
    v_and_b32 v42, v33, v6
    v_and_b32 v43, v33, v7
    s_waitcnt vmcnt(0)
    s_nop 0
    v_mfma_f32_16x16x32_bf16 v[8:11], v[40:43], v[164:167], v[8:11]
    s_lshl_b32 s48, s43, 14
    s_lshl_b32 s49, s42, 12
    s_add_u32 s49, s49, s48
    s_lshl_b32 s50, s44, 9
    s_add_u32 s49, s49, s50
    s_add_u32 s49, s49, 65536
    v_lshrrev_b32 v1, 5, v0
    v_lshlrev_b32 v1, 13, v1
    v_and_b32 v2, 31, v0
    v_lshl_add_u32 v1, v2, 4, v1
    v_mov_b32 v15, s47
    v_perm_b32 v12, v8, v11, s64
    v_perm_b32 v13, v9, v11, s65
    v_perm_b32 v14, v10, v11, s66
    buffer_store_dwordx4 v[12:15], v1, s[12:15], s49 offen sc1
    s_getreg_b32 s99, hwreg(HW_REG_XCC_ID, 0, 4)
    s_lshl_b32 s57, s43, 8
    s_add_u32 s57, s57, 950272
    v_lshlrev_b32 v44, 4, v0
    v_mov_b32 v40, s99
    v_mov_b32 v43, s47
    s_lshl3_add_u32 s48, s42, s44
    s_lshl_b64 exec, 1, s48
    buffer_store_dwordx4 v[40:43], v44, s[12:15], s57 offen sc1
    s_mov_b64 exec, -1
    s_cmp_lg_u32 s45, 0
    s_cbranch_scc1 L_h0_nomlp
    s_mov_b32 s48, 0
    v_lshlrev_b32 v1, 4, v0
    v_lshlrev_b32 v2, 3, v0
    s_mov_b32 s4, s28
    s_mov_b32 s5, s29
    s_mov_b32 s6, 9216
    s_mov_b32 s7, 0x20000
    buffer_load_dwordx4 v[50:53], v1, s[4:7], s48 offen offset:0
    buffer_load_dwordx2 v[54:55], v2, s[4:7], s48 offen offset:1024
    s_mov_b32 s4, s30
    s_mov_b32 s5, s31
    s_mov_b32 s6, 9216
    s_mov_b32 s7, 0x20000
    buffer_load_dwordx4 v[70:73], v1, s[4:7], s48 offen offset:0
    buffer_load_dwordx2 v[74:75], v2, s[4:7], s48 offen offset:1024
    s_mov_b32 s4, s32
    s_mov_b32 s5, s33
    s_mov_b32 s6, 9216
    s_mov_b32 s7, 0x20000
    buffer_load_dwordx4 v[90:93], v1, s[4:7], s48 offen offset:0
    buffer_load_dwordx2 v[94:95], v2, s[4:7], s48 offen offset:1024
L_h0_nomlp:
    s_lshl_b32 s48, s43, 14
    s_lshl_b32 s49, s42, 13
    s_add_u32 s48, s48, s49
    s_add_u32 s48, s48, 65536
    s_add_u32 s49, s48, 4096
    v_lshlrev_b32 v1, 4, v0
    s_mov_b32 s50, 0
    s_sleep 32
L_qpoll:
    buffer_load_dwordx4 v[8:11], v1, s[12:15], s48 offen offset:0 sc1
    buffer_load_dwordx4 v[12:15], v1, s[12:15], s48 offen offset:1024 sc1
    buffer_load_dwordx4 v[16:19], v1, s[12:15], s48 offen offset:2048 sc1
    buffer_load_dwordx4 v[20:23], v1, s[12:15], s48 offen offset:3072 sc1
    buffer_load_dwordx4 v[24:27], v1, s[12:15], s49 offen offset:0 sc1
    buffer_load_dwordx4 v[28:31], v1, s[12:15], s49 offen offset:1024 sc1
    buffer_load_dwordx4 v[32:35], v1, s[12:15], s49 offen offset:2048 sc1
    buffer_load_dwordx4 v[36:39], v1, s[12:15], s49 offen offset:3072 sc1
    v_mov_b32 v43, s47
    s_mov_b64 exec, 0xffff
    buffer_load_dwordx4 v[40:43], v44, s[12:15], s57 offen sc1
    s_mov_b64 exec, -1
    s_waitcnt vmcnt(0)
    v_xor_b32 v2, s47, v11
    v_xor_b32 v3, s47, v15
    v_or_b32 v2, v2, v3
    v_xor_b32 v3, s47, v19
    v_or_b32 v2, v2, v3
    v_xor_b32 v3, s47, v23
    v_or_b32 v2, v2, v3
    v_xor_b32 v3, s47, v27
    v_or_b32 v2, v2, v3
    v_xor_b32 v3, s47, v31
    v_or_b32 v2, v2, v3
    v_xor_b32 v3, s47, v35
    v_or_b32 v2, v2, v3
    v_xor_b32 v3, s47, v39
    v_or_b32 v2, v2, v3
    v_xor_b32 v3, s47, v43
    v_or_b32 v2, v2, v3
    v_cmp_ne_u32 vcc, 0, v2
    s_nop 4
    s_cbranch_vccz L_qgot
    s_sleep 4
    s_add_u32 s50, s50, 1
    s_cmp_lt_u32 s50, 1048576
    s_cbranch_scc1 L_qpoll
L_qgot:
    v_perm_b32 v11, v10, v9, s67
    v_perm_b32 v11, v11, v8, s68
    v_perm_b32 v15, v14, v13, s67
    v_perm_b32 v15, v15, v12, s68
    v_perm_b32 v19, v18, v17, s67
    v_perm_b32 v19, v19, v16, s68
    v_perm_b32 v23, v22, v21, s67
    v_perm_b32 v23, v23, v20, s68
    v_perm_b32 v27, v26, v25, s67
    v_perm_b32 v27, v27, v24, s68
    v_perm_b32 v31, v30, v29, s67
    v_perm_b32 v31, v31, v28, s68
    v_perm_b32 v35, v34, v33, s67
    v_perm_b32 v35, v35, v32, s68
    v_perm_b32 v39, v38, v37, s67
    v_perm_b32 v39, v39, v36, s68
    v_add_f32 v8, v8, v12
    v_add_f32 v16, v16, v20
    v_add_f32 v9, v9, v13
    v_add_f32 v17, v17, v21
    v_add_f32 v10, v10, v14
    v_add_f32 v18, v18, v22
    v_add_f32 v11, v11, v15
    v_add_f32 v19, v19, v23
    v_add_f32 v8, v8, v16
    v_add_f32 v9, v9, v17
    v_add_f32 v10, v10, v18
    v_add_f32 v11, v11, v19
    v_add_f32 v24, v24, v28
    v_add_f32 v32, v32, v36
    v_add_f32 v25, v25, v29
    v_add_f32 v33, v33, v37
    v_add_f32 v26, v26, v30
    v_add_f32 v34, v34, v38
    v_add_f32 v27, v27, v31
    v_add_f32 v35, v35, v39
    v_add_f32 v24, v24, v32
    v_add_f32 v25, v25, v33
    v_add_f32 v26, v26, v34
    v_add_f32 v27, v27, v35
    v_permlane32_swap_b32 v8, v24
    v_permlane32_swap_b32 v9, v25
    v_permlane32_swap_b32 v10, v26
    v_permlane32_swap_b32 v11, v27
    v_add_f32 v8, v8, v24
    v_add_f32 v9, v9, v25
    v_add_f32 v10, v10, v26
    v_add_f32 v11, v11, v27
    v_cvt_pk_bf16_f32 v12, v8, v9
    v_cvt_pk_bf16_f32 v13, v10, v11
    v_lshrrev_b32 v1, 5, v0
    v_lshlrev_b32 v1, 8, v1
    v_and_b32 v2, 15, v0
    v_lshl_add_u32 v1, v2, 4, v1
    v_bfe_u32 v2, v0, 4, 1
    v_lshl_add_u32 v1, v2, 3, v1
    ds_write_b64 v1, v[12:13] offset:0
    v_mov_b32 v14, s47
    v_mov_b32 v15, s55
    v_mov_b32 v2, 0
    v_mov_b32 v3, 1
    ds_write_b64 v2, v[14:15] offset:512
    v_cmp_ne_u32 vcc, s99, v40
    s_nop 1
    s_and_b32 s48, vcc_lo, 0xffff
    v_mov_b32 v16, s48
    ds_write_b32 v2, v16 offset:540
    s_waitcnt lgkmcnt(0)
    ds_write_b32 v2, v3 offset:524
    s_cmp_eq_u32 s45, 0
    s_cbranch_scc1 L_nowo_b
    s_mov_b32 s8, s24
    s_mov_b32 s9, s25
    s_mov_b32 s10, 4718592
    s_mov_b32 s11, 0x20000
    s_lshl_b32 s48, s43, 1
    s_add_u32 s48, s48, s42
    s_mul_i32 s48, s48, 147456
    s_mul_i32 s49, s56, 36864
    s_add_u32 s48, s48, s49
    v_lshrrev_b32 v1, 5, v0
    v_bfe_u32 v2, v0, 4, 1
    v_lshl_add_u32 v1, v1, 2, v2
    v_mul_u32_u24 v1, 1152, v1
    v_and_b32 v2, 15, v0
    v_lshl_add_u32 v1, v2, 4, v1
    s_add_u32 s49, s48, 0
    buffer_load_dwordx4 v[96:99], v1, s[8:11], s49 offen offset:0 nt
    buffer_load_dwordx4 v[104:107], v1, s[8:11], s49 offen offset:256 nt
    buffer_load_dwordx4 v[112:115], v1, s[8:11], s49 offen offset:512 nt
    buffer_load_dwordx4 v[120:123], v1, s[8:11], s49 offen offset:768 nt
    s_add_u32 s49, s48, 9216
    buffer_load_dwordx4 v[100:103], v1, s[8:11], s49 offen offset:0 nt
    buffer_load_dwordx4 v[108:111], v1, s[8:11], s49 offen offset:256 nt
    buffer_load_dwordx4 v[116:119], v1, s[8:11], s49 offen offset:512 nt
    buffer_load_dwordx4 v[124:127], v1, s[8:11], s49 offen offset:768 nt
    s_add_u32 s49, s48, 2304
    buffer_load_dwordx4 v[136:139], v1, s[8:11], s49 offen offset:0 nt
    buffer_load_dwordx4 v[144:147], v1, s[8:11], s49 offen offset:256 nt
    buffer_load_dwordx4 v[152:155], v1, s[8:11], s49 offen offset:512 nt
    buffer_load_dwordx4 v[160:163], v1, s[8:11], s49 offen offset:768 nt
    s_add_u32 s49, s48, 11520
    buffer_load_dwordx4 v[140:143], v1, s[8:11], s49 offen offset:0 nt
    buffer_load_dwordx4 v[148:151], v1, s[8:11], s49 offen offset:256 nt
    buffer_load_dwordx4 v[156:159], v1, s[8:11], s49 offen offset:512 nt
    buffer_load_dwordx4 v[164:167], v1, s[8:11], s49 offen offset:768 nt
    s_add_u32 s49, s48, 18432
    buffer_load_dwordx4 v[176:179], v1, s[8:11], s49 offen offset:0 nt
    buffer_load_dwordx4 v[184:187], v1, s[8:11], s49 offen offset:256 nt
    buffer_load_dwordx4 v[192:195], v1, s[8:11], s49 offen offset:512 nt
    buffer_load_dwordx4 v[200:203], v1, s[8:11], s49 offen offset:768 nt
    s_add_u32 s49, s48, 27648
    buffer_load_dwordx4 v[180:183], v1, s[8:11], s49 offen offset:0 nt
    buffer_load_dwordx4 v[188:191], v1, s[8:11], s49 offen offset:256 nt
    buffer_load_dwordx4 v[196:199], v1, s[8:11], s49 offen offset:512 nt
    buffer_load_dwordx4 v[204:207], v1, s[8:11], s49 offen offset:768 nt
    s_add_u32 s49, s48, 20736
    buffer_load_dwordx4 v[216:219], v1, s[8:11], s49 offen offset:0 nt
    buffer_load_dwordx4 v[224:227], v1, s[8:11], s49 offen offset:256 nt
    buffer_load_dwordx4 v[232:235], v1, s[8:11], s49 offen offset:512 nt
    buffer_load_dwordx4 v[240:243], v1, s[8:11], s49 offen offset:768 nt
    s_add_u32 s49, s48, 29952
    buffer_load_dwordx4 v[220:223], v1, s[8:11], s49 offen offset:0 nt
    buffer_load_dwordx4 v[228:231], v1, s[8:11], s49 offen offset:256 nt
    buffer_load_dwordx4 v[236:239], v1, s[8:11], s49 offen offset:512 nt
    buffer_load_dwordx4 v[244:247], v1, s[8:11], s49 offen offset:768 nt
    s_mov_b32 exec_lo, 0x00ff00ff
    s_mov_b32 exec_hi, 0x00ff00ff
    s_add_u32 s49, s48, 0
    buffer_load_dwordx4 v[128:131], v1, s[8:11], s49 offen offset:1024 nt
    s_add_u32 s49, s48, 9216
    buffer_load_dwordx4 v[132:135], v1, s[8:11], s49 offen offset:1024 nt
    s_add_u32 s49, s48, 2304
    buffer_load_dwordx4 v[168:171], v1, s[8:11], s49 offen offset:1024 nt
    s_add_u32 s49, s48, 11520
    buffer_load_dwordx4 v[172:175], v1, s[8:11], s49 offen offset:1024 nt
    s_add_u32 s49, s48, 18432
    buffer_load_dwordx4 v[208:211], v1, s[8:11], s49 offen offset:1024 nt
    s_add_u32 s49, s48, 27648
    buffer_load_dwordx4 v[212:215], v1, s[8:11], s49 offen offset:1024 nt
    s_add_u32 s49, s48, 20736
    buffer_load_dwordx4 v[248:251], v1, s[8:11], s49 offen offset:1024 nt
    s_add_u32 s49, s48, 29952
    buffer_load_dwordx4 v[252:255], v1, s[8:11], s49 offen offset:1024 nt
    s_mov_b64 exec, -1
    s_branch L_pre_b2
L_nowo_b:
    v_lshlrev_b32 v36, 16, v50
    v_and_b32 v37, 0xffff0000, v50
    v_lshlrev_b32 v38, 16, v51
    v_and_b32 v39, 0xffff0000, v51
    v_lshlrev_b32 v40, 16, v52
    v_and_b32 v41, 0xffff0000, v52
    v_lshlrev_b32 v42, 16, v53
    v_and_b32 v43, 0xffff0000, v53
    v_lshlrev_b32 v44, 16, v54
    v_and_b32 v45, 0xffff0000, v54
    v_lshlrev_b32 v46, 16, v55
    v_and_b32 v47, 0xffff0000, v55
    v_lshlrev_b32 v56, 16, v70
    v_and_b32 v57, 0xffff0000, v70
    v_lshlrev_b32 v58, 16, v71
    v_and_b32 v59, 0xffff0000, v71
    v_lshlrev_b32 v60, 16, v72
    v_and_b32 v61, 0xffff0000, v72
    v_lshlrev_b32 v62, 16, v73
    v_and_b32 v63, 0xffff0000, v73
    v_lshlrev_b32 v64, 16, v74
    v_and_b32 v65, 0xffff0000, v74
    v_lshlrev_b32 v66, 16, v75
    v_and_b32 v67, 0xffff0000, v75
    v_lshlrev_b32 v76, 16, v90
    v_and_b32 v77, 0xffff0000, v90
    v_lshlrev_b32 v78, 16, v91
    v_and_b32 v79, 0xffff0000, v91
    v_lshlrev_b32 v80, 16, v92
    v_and_b32 v81, 0xffff0000, v92
    v_lshlrev_b32 v82, 16, v93
    v_and_b32 v83, 0xffff0000, v93
    v_lshlrev_b32 v84, 16, v94
    v_and_b32 v85, 0xffff0000, v94
    v_lshlrev_b32 v86, 16, v95
    v_and_b32 v87, 0xffff0000, v95
    s_nop 1
L_table:
    s_setprio 1
    s_lshr_b32 s48, s2, 3
    s_mul_i32 s48, s48, 7
    s_add_u32 s48, s48, s44
    s_and_b32 s49, s43, 7
    s_cmp_gt_u32 s44, s49
    s_cselect_b32 s49, 1, 0
    s_sub_u32 s54, s48, s49
    s_mul_i32 s53, s54, 21
    v_mov_b32 v28, 0xc0135761
    v_mov_b32 v30, 0xbdd2d3e8
    v_mov_b32 v32, 1.0
    v_mov_b32 v29, 0xc0135761
    v_mov_b32 v31, 0xbdd2d3e8
    v_mov_b32 v33, 1.0
    s_mul_i32 s48, s56, 84
    v_mov_b32 v3, s48
    s_mov_b32 s57, 21
    s_nop 0
L_tloop:
    s_cmp_ge_u32 s53, 2304
    s_cselect_b32 s48, 30464, 0
    s_add_u32 s48, s48, s53
    s_add_u32 s48, s48, 14336
    s_lshl_b32 s58, s48, 16
    v_mov_b32 v26, 0
    v_mov_b32 v27, 0
    v_pk_mul_f32 v[8:9], s[58:59], v[36:37] op_sel_hi:[0,1]
    v_pk_mul_f32 v[12:13], s[58:59], v[38:39] op_sel_hi:[0,1]
    v_pk_mul_f32 v[16:17], s[58:59], v[40:41] op_sel_hi:[0,1]
    v_cvt_pk_bf16_f32 v8, 0, v8
    v_cvt_pk_bf16_f32 v9, 0, v9
    v_cvt_pk_bf16_f32 v12, 0, v12
    v_cvt_pk_bf16_f32 v13, 0, v13
    v_cvt_pk_bf16_f32 v16, 0, v16
    v_cvt_pk_bf16_f32 v17, 0, v17
    v_pk_add_f32 v[8:9], v[8:9], v[56:57]
    v_pk_add_f32 v[12:13], v[12:13], v[58:59]
    v_pk_add_f32 v[16:17], v[16:17], v[60:61]
    v_cvt_pk_bf16_f32 v8, 0, v8
    v_cvt_pk_bf16_f32 v9, 0, v9
    v_cvt_pk_bf16_f32 v12, 0, v12
    v_cvt_pk_bf16_f32 v13, 0, v13
    v_cvt_pk_bf16_f32 v16, 0, v16
    v_cvt_pk_bf16_f32 v17, 0, v17
    v_pk_mul_f32 v[10:11], v[8:9], v[8:9]
    v_pk_mul_f32 v[14:15], v[12:13], v[12:13]
    v_pk_mul_f32 v[18:19], v[16:17], v[16:17]
    v_pk_fma_f32 v[10:11], v[10:11], v[30:31], v[28:29]
    v_pk_fma_f32 v[14:15], v[14:15], v[30:31], v[28:29]
    v_pk_fma_f32 v[18:19], v[18:19], v[30:31], v[28:29]
    v_pk_mul_f32 v[10:11], v[10:11], v[8:9]
    v_pk_mul_f32 v[14:15], v[14:15], v[12:13]
    v_pk_mul_f32 v[18:19], v[18:19], v[16:17]
    v_exp_f32 v10, v10
    v_exp_f32 v11, v11
    v_exp_f32 v14, v14
    v_exp_f32 v15, v15
    v_exp_f32 v18, v18
    v_exp_f32 v19, v19
    v_pk_add_f32 v[10:11], v[10:11], v[32:33]
    v_pk_add_f32 v[14:15], v[14:15], v[32:33]
    v_pk_add_f32 v[18:19], v[18:19], v[32:33]
    v_rcp_f32 v10, v10
    v_rcp_f32 v11, v11
    v_rcp_f32 v14, v14
    v_rcp_f32 v15, v15
    v_rcp_f32 v18, v18
    v_rcp_f32 v19, v19
    v_pk_mul_f32 v[10:11], v[10:11], v[8:9]
    v_pk_mul_f32 v[14:15], v[14:15], v[12:13]
    v_pk_mul_f32 v[18:19], v[18:19], v[16:17]
    v_cvt_pk_bf16_f32 v10, 0, v10
    v_cvt_pk_bf16_f32 v11, 0, v11
    v_cvt_pk_bf16_f32 v14, 0, v14
    v_cvt_pk_bf16_f32 v15, 0, v15
    v_cvt_pk_bf16_f32 v18, 0, v18
    v_cvt_pk_bf16_f32 v19, 0, v19
    v_pk_fma_f32 v[26:27], v[10:11], v[76:77], v[26:27]
    v_pk_fma_f32 v[26:27], v[14:15], v[78:79], v[26:27]
    v_pk_fma_f32 v[26:27], v[18:19], v[80:81], v[26:27]
    v_pk_mul_f32 v[8:9], s[58:59], v[42:43] op_sel_hi:[0,1]
    v_pk_mul_f32 v[12:13], s[58:59], v[44:45] op_sel_hi:[0,1]
    v_pk_mul_f32 v[16:17], s[58:59], v[46:47] op_sel_hi:[0,1]
    v_cvt_pk_bf16_f32 v8, 0, v8
    v_cvt_pk_bf16_f32 v9, 0, v9
    v_cvt_pk_bf16_f32 v12, 0, v12
    v_cvt_pk_bf16_f32 v13, 0, v13
    v_cvt_pk_bf16_f32 v16, 0, v16
    v_cvt_pk_bf16_f32 v17, 0, v17
    v_pk_add_f32 v[8:9], v[8:9], v[62:63]
    v_pk_add_f32 v[12:13], v[12:13], v[64:65]
    v_pk_add_f32 v[16:17], v[16:17], v[66:67]
    v_cvt_pk_bf16_f32 v8, 0, v8
    v_cvt_pk_bf16_f32 v9, 0, v9
    v_cvt_pk_bf16_f32 v12, 0, v12
    v_cvt_pk_bf16_f32 v13, 0, v13
    v_cvt_pk_bf16_f32 v16, 0, v16
    v_cvt_pk_bf16_f32 v17, 0, v17
    v_pk_mul_f32 v[10:11], v[8:9], v[8:9]
    v_pk_mul_f32 v[14:15], v[12:13], v[12:13]
    v_pk_mul_f32 v[18:19], v[16:17], v[16:17]
    v_pk_fma_f32 v[10:11], v[10:11], v[30:31], v[28:29]
    v_pk_fma_f32 v[14:15], v[14:15], v[30:31], v[28:29]
    v_pk_fma_f32 v[18:19], v[18:19], v[30:31], v[28:29]
    v_pk_mul_f32 v[10:11], v[10:11], v[8:9]
    v_pk_mul_f32 v[14:15], v[14:15], v[12:13]
    v_pk_mul_f32 v[18:19], v[18:19], v[16:17]
    v_exp_f32 v10, v10
    v_exp_f32 v11, v11
    v_exp_f32 v14, v14
    v_exp_f32 v15, v15
    v_exp_f32 v18, v18
    v_exp_f32 v19, v19
    v_pk_add_f32 v[10:11], v[10:11], v[32:33]
    v_pk_add_f32 v[14:15], v[14:15], v[32:33]
    v_pk_add_f32 v[18:19], v[18:19], v[32:33]
    v_rcp_f32 v10, v10
    v_rcp_f32 v11, v11
    v_rcp_f32 v14, v14
    v_rcp_f32 v15, v15
    v_rcp_f32 v18, v18
    v_rcp_f32 v19, v19
    v_pk_mul_f32 v[10:11], v[10:11], v[8:9]
    v_pk_mul_f32 v[14:15], v[14:15], v[12:13]
    v_pk_mul_f32 v[18:19], v[18:19], v[16:17]
    v_cvt_pk_bf16_f32 v10, 0, v10
    v_cvt_pk_bf16_f32 v11, 0, v11
    v_cvt_pk_bf16_f32 v14, 0, v14
    v_cvt_pk_bf16_f32 v15, 0, v15
    v_cvt_pk_bf16_f32 v18, 0, v18
    v_cvt_pk_bf16_f32 v19, 0, v19
    v_pk_fma_f32 v[26:27], v[10:11], v[82:83], v[26:27]
    v_pk_fma_f32 v[26:27], v[14:15], v[84:85], v[26:27]
    v_pk_fma_f32 v[26:27], v[18:19], v[86:87], v[26:27]
    s_cmp_eq_u32 s56, 0
    s_cbranch_scc1 L_tskip
    v_pk_mul_f32 v[8:9], s[58:59], v[48:49] op_sel_hi:[0,1]
    v_pk_mul_f32 v[12:13], s[58:59], v[50:51] op_sel_hi:[0,1]
    v_pk_mul_f32 v[16:17], s[58:59], v[52:53] op_sel_hi:[0,1]
    v_pk_mul_f32 v[20:21], s[58:59], v[54:55] op_sel_hi:[0,1]
    v_cvt_pk_bf16_f32 v8, 0, v8
    v_cvt_pk_bf16_f32 v9, 0, v9
    v_cvt_pk_bf16_f32 v12, 0, v12
    v_cvt_pk_bf16_f32 v13, 0, v13
    v_cvt_pk_bf16_f32 v16, 0, v16
    v_cvt_pk_bf16_f32 v17, 0, v17
    v_cvt_pk_bf16_f32 v20, 0, v20
    v_cvt_pk_bf16_f32 v21, 0, v21
    v_pk_add_f32 v[8:9], v[8:9], v[68:69]
    v_pk_add_f32 v[12:13], v[12:13], v[70:71]
    v_pk_add_f32 v[16:17], v[16:17], v[72:73]
    v_pk_add_f32 v[20:21], v[20:21], v[74:75]
    v_cvt_pk_bf16_f32 v8, 0, v8
    v_cvt_pk_bf16_f32 v9, 0, v9
    v_cvt_pk_bf16_f32 v12, 0, v12
    v_cvt_pk_bf16_f32 v13, 0, v13
    v_cvt_pk_bf16_f32 v16, 0, v16
    v_cvt_pk_bf16_f32 v17, 0, v17
    v_cvt_pk_bf16_f32 v20, 0, v20
    v_cvt_pk_bf16_f32 v21, 0, v21
    v_pk_mul_f32 v[10:11], v[8:9], v[8:9]
    v_pk_mul_f32 v[14:15], v[12:13], v[12:13]
    v_pk_mul_f32 v[18:19], v[16:17], v[16:17]
    v_pk_mul_f32 v[22:23], v[20:21], v[20:21]
    v_pk_fma_f32 v[10:11], v[10:11], v[30:31], v[28:29]
    v_pk_fma_f32 v[14:15], v[14:15], v[30:31], v[28:29]
    v_pk_fma_f32 v[18:19], v[18:19], v[30:31], v[28:29]
    v_pk_fma_f32 v[22:23], v[22:23], v[30:31], v[28:29]
    v_pk_mul_f32 v[10:11], v[10:11], v[8:9]
    v_pk_mul_f32 v[14:15], v[14:15], v[12:13]
    v_pk_mul_f32 v[18:19], v[18:19], v[16:17]
    v_pk_mul_f32 v[22:23], v[22:23], v[20:21]
    v_exp_f32 v10, v10
    v_exp_f32 v11, v11
    v_exp_f32 v14, v14
    v_exp_f32 v15, v15
    v_exp_f32 v18, v18
    v_exp_f32 v19, v19
    v_exp_f32 v22, v22
    v_exp_f32 v23, v23
    v_pk_add_f32 v[10:11], v[10:11], v[32:33]
    v_pk_add_f32 v[14:15], v[14:15], v[32:33]
    v_pk_add_f32 v[18:19], v[18:19], v[32:33]
    v_pk_add_f32 v[22:23], v[22:23], v[32:33]
    v_rcp_f32 v10, v10
    v_rcp_f32 v11, v11
    v_rcp_f32 v14, v14
    v_rcp_f32 v15, v15
    v_rcp_f32 v18, v18
    v_rcp_f32 v19, v19
    v_rcp_f32 v22, v22
    v_rcp_f32 v23, v23
    v_pk_mul_f32 v[10:11], v[10:11], v[8:9]
    v_pk_mul_f32 v[14:15], v[14:15], v[12:13]
    v_pk_mul_f32 v[18:19], v[18:19], v[16:17]
    v_pk_mul_f32 v[22:23], v[22:23], v[20:21]
    v_cvt_pk_bf16_f32 v10, 0, v10
    v_cvt_pk_bf16_f32 v11, 0, v11
    v_cvt_pk_bf16_f32 v14, 0, v14
    v_cvt_pk_bf16_f32 v15, 0, v15
    v_cvt_pk_bf16_f32 v18, 0, v18
    v_cvt_pk_bf16_f32 v19, 0, v19
    v_cvt_pk_bf16_f32 v22, 0, v22
    v_cvt_pk_bf16_f32 v23, 0, v23
    v_pk_fma_f32 v[26:27], v[10:11], v[88:89], v[26:27]
    v_pk_fma_f32 v[26:27], v[14:15], v[90:91], v[26:27]
    v_pk_fma_f32 v[26:27], v[18:19], v[92:93], v[26:27]
    v_pk_fma_f32 v[26:27], v[22:23], v[94:95], v[26:27]
    s_nop 1
L_tskip:
    v_add_f32 v26, v26, v27
    s_nop 1
    v_add_f32_dpp v26, v26, v26 quad_perm:[1,0,3,2] row_mask:0xf bank_mask:0xf
    s_nop 1
    v_add_f32_dpp v26, v26, v26 quad_perm:[2,3,0,1] row_mask:0xf bank_mask:0xf
    s_nop 1
    v_add_f32_dpp v26, v26, v26 row_half_mirror row_mask:0xf bank_mask:0xf
    s_nop 1
    v_add_f32_dpp v26, v26, v26 row_ror:8 row_mask:0xf bank_mask:0xf
    v_mov_b32 v27, v26
    s_nop 1
    v_permlane16_swap_b32 v26, v27
    v_add_f32 v26, v26, v27
    v_mov_b32 v27, v26
    s_nop 1
    v_permlane32_swap_b32 v26, v27
    v_add_f32 v26, v26, v27
    ds_write_b32 v3, v26 offset:576
    v_add_u32 v3, 4, v3
    s_add_u32 s53, s53, 1
    s_sub_u32 s57, s57, 1
    s_cmp_lg_u32 s57, 0
    s_cbranch_scc1 L_tloop
    v_mov_b32 v2, 0
    s_mov_b32 s50, 0
    s_nop 0
L_tflag:
    ds_read_b32 v8, v2 offset:524
    s_waitcnt lgkmcnt(0)
    v_readfirstlane_b32 s48, v8
    s_nop 1
    s_cmp_lg_u32 s48, 0
    s_nop 0
    s_cbranch_scc1 L_tflag_ok
    s_sleep 1
    s_add_u32 s50, s50, 1
    s_cmp_lt_u32 s50, 16777216
    s_cbranch_scc1 L_tflag
L_tflag_ok:
    ds_read_b64 v[10:11], v2 offset:512
    v_mov_b32 v8, 1
    s_mov_b64 exec, 1
    ds_add_rtn_u32 v9, v2, v8 offset:520
    s_mov_b64 exec, -1
    s_waitcnt lgkmcnt(0)
    v_readfirstlane_b32 s47, v10
    v_readfirstlane_b32 s55, v11
    v_readfirstlane_b32 s48, v9
    s_nop 1
    s_cmp_eq_u32 s48, 3
    s_nop 0
    s_cbranch_scc0 L_tdone
    v_lshlrev_b32 v3, 2, v0
    s_mov_b64 exec, 0x1fffff
    ds_read_b32 v8, v3 offset:576
    ds_read_b32 v9, v3 offset:660
    ds_read_b32 v10, v3 offset:744
    ds_read_b32 v11, v3 offset:828
    v_lshlrev_b32 v3, 1, v0
    s_lshl_b32 s48, s69, 16
    s_waitcnt lgkmcnt(0)
    v_add_f32 v8, v8, v9
    v_add_f32 v10, v10, v11
    v_add_f32 v8, v8, v10
    v_cvt_pk_bf16_f32 v8, 0, v8
    v_add_f32 v8, s48, v8
    v_cvt_pk_bf16_f32 v8, v8, 0
    ds_write_b16 v3, v8 offset:928
    s_mov_b64 exec, 15
    v_mul_u32_u24 v3, 12, v0
    s_waitcnt lgkmcnt(0)
    ds_read_b32 v8, v3 offset:928
    ds_read_b32 v9, v3 offset:932
    ds_read_b32 v10, v3 offset:936
    v_mov_b32 v11, s47
    v_lshlrev_b32 v3, 4, v0
    s_lshl_b32 s48, s54, 6
    s_add_u32 s48, s48, 917504
    s_waitcnt lgkmcnt(0)
    buffer_store_dwordx4 v[8:11], v3, s[12:15], s48 offen sc1
    s_mov_b64 exec, -1
    s_nop 0
L_tdone:
    s_cmp_lg_u32 s46, 0
    s_cbranch_scc1 L_final
    s_cmp_eq_u32 s56, 1
    s_cbranch_scc0 L_nowarm
    s_mov_b32 s98, 1
    v_mov_b32 v2, 0
    v_mov_b32 v87, 0
    s_nop 0
    s_branch L_pub
L_nowarm:
    s_endpgm
L_pre_b2:
    v_mov_b32 v3, 0
    s_mov_b32 s50, 0
    s_nop 0
L_oflag:
    ds_read_b32 v8, v3 offset:524
    s_waitcnt lgkmcnt(0)
    v_readfirstlane_b32 s48, v8
    s_nop 1
    s_cmp_lg_u32 s48, 0
    s_nop 0
    s_cbranch_scc1 L_oflag_ok
    s_sleep 1
    s_add_u32 s50, s50, 1
    s_cmp_lt_u32 s50, 16777216
    s_cbranch_scc1 L_oflag
L_oflag_ok:
    ds_read_b64 v[10:11], v3 offset:512
    s_waitcnt vmcnt(0) lgkmcnt(0)
    v_readfirstlane_b32 s47, v10
    s_setprio 0
    s_cmp_eq_u32 s56, 1
    s_nop 1
    s_cbranch_scc0 L_owner_setup
    s_mov_b32 s98, 2
    v_mov_b32 v2, 0
    v_mov_b32 v87, 0
    s_nop 0
    s_branch L_pub
L_owner_setup:
    v_and_b32 v4, 3, v0
    v_xor_b32 v5, 1, v4
    v_lshl_add_u32 v4, v5, 2, v4
    v_mul_u32_u24 v4, 0x1111, v4
    s_mov_b32 s90, 0x0f0f0f0f
    s_mov_b32 s91, 0x0f0f0f0f
    s_lshl_b32 s57, s43, 1
    s_add_u32 s57, s57, s42
    s_mul_i32 s49, s57, 10240
    s_add_u32 s49, s49, 393216
    v_and_b32 v1, 15, v0
    v_lshlrev_b32 v1, 4, v1
    v_add_u32 v1, 8192, v1
    v_lshrrev_b32 v2, 4, v0
    s_lshl_b32 s50, s56, 3
    v_add_lshl_u32 v2, v2, s50, 7
    v_bfe_u32 v5, v0, 3, 1
    v_lshl_add_u32 v2, v5, 12, v2
    v_and_b32 v5, 7, v0
    v_lshl_add_u32 v2, v5, 4, v2
    s_mul_i32 s50, s56, 4608
    s_add_u32 s50, s50, 138496
    v_lshrrev_b32 v36, 5, v0
    v_mul_u32_u24 v36, 2304, v36
    v_and_b32 v37, 15, v0
    v_lshl_add_u32 v36, v37, 5, v36
    v_bfe_u32 v37, v0, 4, 1
    v_lshl_add_u32 v36, v37, 4, v36
    v_add_u32 v36, s50, v36
    s_mul_i32 s50, s56, 48
    v_add_u32 v37, s50, v0
    v_mul_u32_u24 v37, 24, v37
    v_add_u32 v37, 138496, v37
    v_lshlrev_b32 v38, 4, v0
    s_lshr_b32 s50, s56, 1
    s_lshl_b32 s53, s50, 3
    s_lshl_b32 s50, s50, 5
    s_add_u32 s50, s50, s57
    s_mul_i32 s50, s50, 1536
    s_and_b32 s51, s56, 1
    s_mul_i32 s51, s51, 768
    s_add_u32 s51, s50, s51
    s_add_u32 s51, s51, 786432
    v_mov_b32 v35, s47
    v_mov_b32 v3, 0
    s_mov_b32 s98, 1
    s_branch L_ogot
L_owner_real:
    s_mov_b64 exec, -1
    s_mov_b32 s98, 0
    buffer_load_dwordx4 v[8:11], v1, s[12:15], s49 offen sc1
    buffer_load_dwordx4 v[12:15], v2, s[12:15], s49 offen sc1
    buffer_load_dwordx4 v[16:19], v2, s[12:15], s49 offen offset:512 sc1
    v_mov_b32 v72, 0
    v_mov_b32 v73, 0
    v_mov_b32 v74, 0
    v_mov_b32 v75, 0
    v_mov_b32 v76, 0
    v_mov_b32 v77, 0
    v_mov_b32 v78, 0
    v_mov_b32 v79, 0
    v_mov_b32 v80, 0
    v_mov_b32 v81, 0
    v_mov_b32 v82, 0
    v_mov_b32 v83, 0
    v_mov_b32 v84, 0
    v_mov_b32 v85, 0
    v_mov_b32 v86, 0
    v_mov_b32 v87, 0
    v_mov_b32 v88, 0
    v_mov_b32 v89, 0
    v_mov_b32 v90, 0
    v_mov_b32 v91, 0
    s_mov_b32 s50, 0
    s_nop 0
L_odone:
    ds_read_b32 v22, v3 offset:532
    s_waitcnt lgkmcnt(0)
    v_readfirstlane_b32 s48, v22
    s_nop 1
    s_cmp_lg_u32 s48, 0
    s_nop 0
    s_cbranch_scc1 L_odone_ok
    s_sleep 1
    s_add_u32 s50, s50, 1
    s_cmp_lt_u32 s50, 16777216
    s_cbranch_scc1 L_odone
L_odone_ok:
    s_setprio 3
    s_mov_b32 s50, 0
L_opoll:
    buffer_load_dwordx4 v[8:11], v1, s[12:15], s49 offen sc1
    buffer_load_dwordx4 v[12:15], v2, s[12:15], s49 offen sc1
    buffer_load_dwordx4 v[16:19], v2, s[12:15], s49 offen offset:512 sc1
    s_waitcnt vmcnt(0)
    v_xor_b32 v20, s47, v11
    v_xor_b32 v21, s47, v15
    v_or_b32 v20, v20, v21
    v_xor_b32 v21, s47, v19
    v_or_b32 v20, v20, v21
    v_cmp_ne_u32 vcc, 0, v20
    s_nop 4
    s_cbranch_vccz L_ogot
    s_add_u32 s50, s50, 1
    s_cmp_lt_u32 s50, 1048576
    s_cbranch_scc1 L_opoll
L_ogot:
    v_max_f32_dpp v21, v8, v8 quad_perm:[1,0,3,2] row_mask:0xf bank_mask:0xf
    v_perm_b32 v22, v14, v13, s67
    v_perm_b32 v23, v18, v17, s67
    v_max_f32_dpp v21, v21, v21 quad_perm:[2,3,0,1] row_mask:0xf bank_mask:0xf
    v_perm_b32 v22, v22, v12, s68
    v_perm_b32 v23, v23, v16, s68
    v_max_f32_dpp v21, v21, v21 row_half_mirror row_mask:0xf bank_mask:0xf
    v_sub_f32 v21, v8, v21
    v_mul_f32 v21, s62, v21
    v_exp_f32 v21, v21
    s_nop 0
    v_mul_f32 v56, v21, v12
    v_mul_f32 v57, v21, v13
    v_mul_f32 v58, v21, v14
    v_mul_f32 v59, v21, v22
    v_mul_f32 v60, v21, v16
    v_mul_f32 v61, v21, v17
    v_mul_f32 v62, v21, v18
    v_mul_f32 v63, v21, v23
    v_mul_f32 v64, v21, v9
    s_nop 1
L_osum:
    v_add_f32_dpp v56, v56, v56 quad_perm:[1,0,3,2] row_mask:0xf bank_mask:0xf
    v_add_f32_dpp v57, v57, v57 quad_perm:[1,0,3,2] row_mask:0xf bank_mask:0xf
    v_add_f32_dpp v58, v58, v58 quad_perm:[1,0,3,2] row_mask:0xf bank_mask:0xf
    v_add_f32_dpp v59, v59, v59 quad_perm:[1,0,3,2] row_mask:0xf bank_mask:0xf
    v_add_f32_dpp v60, v60, v60 quad_perm:[1,0,3,2] row_mask:0xf bank_mask:0xf
    v_add_f32_dpp v61, v61, v61 quad_perm:[1,0,3,2] row_mask:0xf bank_mask:0xf
    v_add_f32_dpp v62, v62, v62 quad_perm:[1,0,3,2] row_mask:0xf bank_mask:0xf
    v_add_f32_dpp v63, v63, v63 quad_perm:[1,0,3,2] row_mask:0xf bank_mask:0xf
    v_add_f32_dpp v64, v64, v64 quad_perm:[1,0,3,2] row_mask:0xf bank_mask:0xf
    v_add_f32_dpp v56, v56, v56 quad_perm:[2,3,0,1] row_mask:0xf bank_mask:0xf
    v_add_f32_dpp v57, v57, v57 quad_perm:[2,3,0,1] row_mask:0xf bank_mask:0xf
    v_add_f32_dpp v58, v58, v58 quad_perm:[2,3,0,1] row_mask:0xf bank_mask:0xf
    v_add_f32_dpp v59, v59, v59 quad_perm:[2,3,0,1] row_mask:0xf bank_mask:0xf
    v_add_f32_dpp v60, v60, v60 quad_perm:[2,3,0,1] row_mask:0xf bank_mask:0xf
    v_add_f32_dpp v61, v61, v61 quad_perm:[2,3,0,1] row_mask:0xf bank_mask:0xf
    v_add_f32_dpp v62, v62, v62 quad_perm:[2,3,0,1] row_mask:0xf bank_mask:0xf
    v_add_f32_dpp v63, v63, v63 quad_perm:[2,3,0,1] row_mask:0xf bank_mask:0xf
    v_add_f32_dpp v64, v64, v64 quad_perm:[2,3,0,1] row_mask:0xf bank_mask:0xf
    v_add_f32_dpp v56, v56, v56 row_half_mirror row_mask:0xf bank_mask:0xf
    v_add_f32_dpp v57, v57, v57 row_half_mirror row_mask:0xf bank_mask:0xf
    v_cvt_pk_bf16_f32 v56, v56, 0
    v_cvt_pk_bf16_f32 v57, v57, 0
    v_cndmask_b32 v40, 0, v56, s[90:91]
    v_cndmask_b32 v41, v56, 0, s[90:91]
    v_cndmask_b32 v42, 0, v57, s[90:91]
    v_cndmask_b32 v43, v57, 0, s[90:91]
    s_nop 1
    v_smfmac_f32_16x16x64_bf16 v[72:75], v[40:43], v[96:103], v4
    v_add_f32_dpp v58, v58, v58 row_half_mirror row_mask:0xf bank_mask:0xf
    v_add_f32_dpp v59, v59, v59 row_half_mirror row_mask:0xf bank_mask:0xf
    v_cvt_pk_bf16_f32 v58, v58, 0
    v_smfmac_f32_16x16x64_bf16 v[76:79], v[40:43], v[104:111], v4
    v_cvt_pk_bf16_f32 v59, v59, 0
    v_cndmask_b32 v44, 0, v58, s[90:91]
    v_cndmask_b32 v45, v58, 0, s[90:91]
    v_smfmac_f32_16x16x64_bf16 v[80:83], v[40:43], v[112:119], v4
    v_cndmask_b32 v46, 0, v59, s[90:91]
    v_cndmask_b32 v47, v59, 0, s[90:91]
    s_nop 1
    v_smfmac_f32_16x16x64_bf16 v[72:75], v[44:47], v[136:143], v4
    v_add_f32_dpp v60, v60, v60 row_half_mirror row_mask:0xf bank_mask:0xf
    v_add_f32_dpp v61, v61, v61 row_half_mirror row_mask:0xf bank_mask:0xf
    v_cvt_pk_bf16_f32 v60, v60, 0
    v_smfmac_f32_16x16x64_bf16 v[76:79], v[44:47], v[144:151], v4
    v_cvt_pk_bf16_f32 v61, v61, 0
    v_cndmask_b32 v48, 0, v60, s[90:91]
    v_cndmask_b32 v49, v60, 0, s[90:91]
    v_smfmac_f32_16x16x64_bf16 v[80:83], v[44:47], v[152:159], v4
    v_cndmask_b32 v50, 0, v61, s[90:91]
    v_cndmask_b32 v51, v61, 0, s[90:91]
    s_nop 1
    v_smfmac_f32_16x16x64_bf16 v[72:75], v[48:51], v[176:183], v4
    v_add_f32_dpp v62, v62, v62 row_half_mirror row_mask:0xf bank_mask:0xf
    v_add_f32_dpp v63, v63, v63 row_half_mirror row_mask:0xf bank_mask:0xf
    v_cvt_pk_bf16_f32 v62, v62, 0
    v_smfmac_f32_16x16x64_bf16 v[76:79], v[48:51], v[184:191], v4
    v_cvt_pk_bf16_f32 v63, v63, 0
    v_cndmask_b32 v52, 0, v62, s[90:91]
    v_cndmask_b32 v53, v62, 0, s[90:91]
    v_smfmac_f32_16x16x64_bf16 v[80:83], v[48:51], v[192:199], v4
    v_cndmask_b32 v54, 0, v63, s[90:91]
    v_cndmask_b32 v55, v63, 0, s[90:91]
    s_nop 1
    v_smfmac_f32_16x16x64_bf16 v[72:75], v[52:55], v[216:223], v4
    v_add_f32_dpp v64, v64, v64 row_half_mirror row_mask:0xf bank_mask:0xf
    v_rcp_f32 v64, v64
    v_smfmac_f32_16x16x64_bf16 v[76:79], v[52:55], v[224:231], v4
    v_smfmac_f32_16x16x64_bf16 v[80:83], v[52:55], v[232:239], v4
    v_smfmac_f32_16x16x64_bf16 v[84:87], v[40:43], v[120:127], v4
    v_smfmac_f32_16x16x64_bf16 v[84:87], v[44:47], v[160:167], v4
    v_smfmac_f32_16x16x64_bf16 v[84:87], v[48:51], v[200:207], v4
    v_smfmac_f32_16x16x64_bf16 v[84:87], v[52:55], v[240:247], v4
    ds_write_b128 v36, v[72:75] offset:0
    s_nop 1
    ds_write_b128 v36, v[76:79] offset:512
    v_smfmac_f32_16x16x64_bf16 v[88:91], v[40:43], v[128:135], v4
    ds_write_b128 v36, v[80:83] offset:1024
    v_smfmac_f32_16x16x64_bf16 v[88:91], v[44:47], v[168:175], v4
    v_smfmac_f32_16x16x64_bf16 v[88:91], v[48:51], v[208:215], v4
    v_readlane_b32 s52, v64, s53
    v_smfmac_f32_16x16x64_bf16 v[88:91], v[52:55], v[248:255], v4
    ds_write_b128 v36, v[84:87] offset:1536
    s_mov_b32 exec_lo, 0x00ff00ff
    s_mov_b32 exec_hi, 0x00ff00ff
    s_nop 4
    ds_write_b128 v36, v[88:91] offset:2048
    s_mov_b32 exec_lo, -1
    s_mov_b32 exec_hi, 0xffff
    s_waitcnt vmcnt(0) lgkmcnt(0)
    s_cmp_lg_u32 s98, 0
    s_cbranch_scc1 L_o_nobar
    s_barrier
L_o_nobar:
    ds_read_b64 v[8:9], v37 offset:0
    ds_read_b64 v[10:11], v37 offset:8
    ds_read_b64 v[12:13], v37 offset:16
    ds_read_b64 v[14:15], v37 offset:4608
    ds_read_b64 v[16:17], v37 offset:4616
    ds_read_b64 v[18:19], v37 offset:4624
    ds_read_b64 v[20:21], v37 offset:9216
    ds_read_b64 v[22:23], v37 offset:9224
    ds_read_b64 v[24:25], v37 offset:9232
    ds_read_b64 v[26:27], v37 offset:13824
    ds_read_b64 v[28:29], v37 offset:13832
    ds_read_b64 v[30:31], v37 offset:13840
    s_waitcnt lgkmcnt(6)
    v_add_f32 v8, v8, v14
    v_add_f32 v9, v9, v15
    v_add_f32 v10, v10, v16
    v_add_f32 v11, v11, v17
    v_add_f32 v12, v12, v18
    v_add_f32 v13, v13, v19
    s_waitcnt lgkmcnt(3)
    v_add_f32 v8, v8, v20
    v_add_f32 v9, v9, v21
    v_add_f32 v10, v10, v22
    v_add_f32 v11, v11, v23
    v_add_f32 v12, v12, v24
    v_add_f32 v13, v13, v25
    s_waitcnt lgkmcnt(0)
    v_add_f32 v8, v8, v26
    v_add_f32 v9, v9, v27
    v_add_f32 v10, v10, v28
    v_add_f32 v11, v11, v29
    v_add_f32 v12, v12, v30
    v_add_f32 v13, v13, v31
    v_mul_f32 v8, s52, v8
    v_mul_f32 v9, s52, v9
    v_mul_f32 v10, s52, v10
    v_mul_f32 v11, s52, v11
    v_mul_f32 v12, s52, v12
    v_mul_f32 v13, s52, v13
    v_cvt_pk_bf16_f32 v32, v8, v9
    v_cvt_pk_bf16_f32 v33, v10, v11
    v_cvt_pk_bf16_f32 v34, v12, v13
    s_cmp_lg_u32 s98, 0
    s_cbranch_scc1 L_owner_real
    buffer_store_dwordx4 v[32:35], v38, s[12:15], s51 offen sc1
    s_mov_b64 exec, -1
    s_endpgm
L_final:
    s_sub_u32 s46, s46, 1
    s_waitcnt lgkmcnt(0)
    v_and_b32 v8, 1, v0
    v_cmp_eq_u32 vcc, 1, v8
    v_mov_b32 v8, 0x3f80
    v_mov_b32 v9, 0x3f800000
    v_cndmask_b32 v8, v8, v9, vcc
    v_and_b32 v9, 14, v0
    v_cmp_eq_u32 vcc, 0, v9
    s_nop 1
    v_cndmask_b32 v4, 0, v8, vcc
    v_cmp_eq_u32 vcc, 4, v9
    s_nop 1
    v_cndmask_b32 v5, 0, v8, vcc
    v_cmp_eq_u32 vcc, 8, v9
    s_nop 1
    v_cndmask_b32 v6, 0, v8, vcc
    v_mov_b32 v7, 0
    v_and_b32 v1, 15, v0
    s_mul_i32 s52, s46, 1152
    s_mul_i32 s48, s3, 192
    s_add_u32 s52, s52, s48
    v_mul_u32_u24 v3, 12, v1
    v_lshrrev_b32 v2, 4, v0
    v_lshl_add_u32 v3, v2, 2, v3
    s_mov_b32 s4, s16
    s_mov_b32 s5, s17
    s_mov_b32 s6, 2304
    s_mov_b32 s7, 0x20000
    s_mov_b32 s8, s36
    s_mov_b32 s9, s37
    s_mov_b32 s10, 2304
    s_mov_b32 s11, 0x20000
    buffer_load_dword v56, v3, s[4:7], s52 offen
    v_mul_u32_u24 v2, 1536, v2
    v_lshl_add_u32 v34, v1, 4, v2
    s_lshl_b32 s48, s3, 3
    v_mov_b32 v1, s48
    v_mov_b32 v2, 0
    s_mul_i32 s57, s46, 49152
    s_lshl_b32 s49, s3, 8
    s_add_u32 s57, s57, s49
    s_add_u32 s57, s57, 786432
    s_mov_b32 s88, -1
    s_mov_b32 s89, 0xffff
    s_movk_i32 s56, 4608
    s_mov_b32 s54, 109824
    s_waitcnt vmcnt(0)
    v_lshlrev_b32 v40, 16, v56
    v_and_b32 v41, 0xffff0000, v56
    v_cndmask_b32 v40, 0, v40, s[88:89]
    v_cndmask_b32 v41, 0, v41, s[88:89]
    v_mov_b32 v35, s55
    s_or_b32 s99, s46, s3
    s_cmp_lt_u32 s3, 4
    s_cbranch_scc1 L_final_real
    s_mov_b32 s98, 1
    s_branch L_fgot
L_final_real:
    s_mov_b64 exec, -1
    s_mov_b32 s98, 0
    v_mov_b32 v8, 0
    v_mov_b32 v9, 0
    v_mov_b32 v10, 0
    v_mov_b32 v11, 0
    v_mov_b32 v48, 0
    v_mov_b32 v49, 0
    s_mov_b32 s50, 0
    s_nop 0
L_fdone:
    ds_read_b32 v13, v2 offset:532
    s_waitcnt lgkmcnt(0)
    v_readfirstlane_b32 s48, v13
    s_nop 1
    s_cmp_lg_u32 s48, 0
    s_nop 0
    s_cbranch_scc1 L_fdone_ok
    s_sleep 1
    s_add_u32 s50, s50, 1
    s_cmp_lt_u32 s50, 16777216
    s_cbranch_scc1 L_fdone
L_fdone_ok:
    s_setprio 3
    s_cmp_lt_u32 s3, 4
    s_cbranch_scc1 L_nogather
    s_sub_u32 s48, s3, 4
    s_mul_i32 s86, s48, 224
    s_mul_i32 s48, s48, 3584
    s_add_u32 s48, s48, 917504
    v_lshlrev_b32 v100, 4, v0
    s_mov_b32 s50, 0
    s_nop 0
L_gpoll:
    v_mov_b32 v79, s47
    buffer_load_dwordx4 v[64:67], v100, s[12:15], s48 offen offset:0 sc1
    buffer_load_dwordx4 v[68:71], v100, s[12:15], s48 offen offset:1024 sc1
    buffer_load_dwordx4 v[72:75], v100, s[12:15], s48 offen offset:2048 sc1
    s_mov_b32 exec_hi, 0
    buffer_load_dwordx4 v[76:79], v100, s[12:15], s48 offen offset:3072 sc1
    s_mov_b32 exec_hi, -1
    v_add_u32 v101, s86, v0
    v_lshrrev_b32 v102, 2, v101
    v_mul_u32_u24 v102, 42, v102
    v_and_b32 v101, 3, v101
    v_mad_u32_u24 v102, v101, 12, v102
    v_add_u32 v102, 138496, v102
    v_cmp_ne_u32 s[90:91], 3, v101
    s_waitcnt vmcnt(0)
    v_xor_b32 v103, s47, v67
    v_xor_b32 v104, s47, v71
    v_or_b32 v103, v103, v104
    v_xor_b32 v104, s47, v75
    v_or_b32 v103, v103, v104
    v_xor_b32 v104, s47, v79
    v_or_b32 v103, v103, v104
    v_cmp_ne_u32 vcc, 0, v103
    s_nop 4
    s_cbranch_vccz L_ggot
    s_sleep 4
    s_add_u32 s50, s50, 1
    s_cmp_lt_u32 s50, 1048576
    s_cbranch_scc1 L_gpoll
L_ggot:
    ds_write_b16 v102, v64 offset:0
    ds_write_b16_d16_hi v102, v64 offset:2
    ds_write_b16 v102, v65 offset:4
    ds_write_b16 v102, v68 offset:672
    ds_write_b16_d16_hi v102, v68 offset:674
    ds_write_b16 v102, v69 offset:676
    ds_write_b16 v102, v72 offset:1344
    ds_write_b16_d16_hi v102, v72 offset:1346
    ds_write_b16 v102, v73 offset:1348
    s_mov_b32 exec_hi, 0
    ds_write_b16 v102, v76 offset:2016
    ds_write_b16_d16_hi v102, v76 offset:2018
    ds_write_b16 v102, v77 offset:2020
    s_mov_b64 exec, s[90:91]
    ds_write_b16_d16_hi v102, v65 offset:6
    ds_write_b16 v102, v66 offset:8
    ds_write_b16_d16_hi v102, v66 offset:10
    ds_write_b16_d16_hi v102, v69 offset:678
    ds_write_b16 v102, v70 offset:680
    ds_write_b16_d16_hi v102, v70 offset:682
    ds_write_b16_d16_hi v102, v73 offset:1350
    ds_write_b16 v102, v74 offset:1352
    ds_write_b16_d16_hi v102, v74 offset:1354
    s_mov_b32 exec_hi, 0
    ds_write_b16_d16_hi v102, v77 offset:2022
    ds_write_b16 v102, v78 offset:2024
    ds_write_b16_d16_hi v102, v78 offset:2026
    s_mov_b64 exec, -1
    s_cmp_ge_u32 s3, 6
    s_cbranch_scc1 L_end
L_nogather:
    s_mov_b32 s53, 0xff
    s_mov_b32 s50, 0
    s_add_u32 s49, s57, 0
    buffer_load_dwordx4 v[64:67], v34, s[12:15], s49 offen sc1
    s_add_u32 s49, s57, 6144
    buffer_load_dwordx4 v[68:71], v34, s[12:15], s49 offen sc1
    s_add_u32 s49, s57, 12288
    buffer_load_dwordx4 v[72:75], v34, s[12:15], s49 offen sc1
    s_add_u32 s49, s57, 18432
    buffer_load_dwordx4 v[76:79], v34, s[12:15], s49 offen sc1
    s_add_u32 s49, s57, 24576
    buffer_load_dwordx4 v[80:83], v34, s[12:15], s49 offen sc1
    s_add_u32 s49, s57, 30720
    buffer_load_dwordx4 v[84:87], v34, s[12:15], s49 offen sc1
    s_add_u32 s49, s57, 36864
    buffer_load_dwordx4 v[88:91], v34, s[12:15], s49 offen sc1
    s_add_u32 s49, s57, 43008
    buffer_load_dwordx4 v[92:95], v34, s[12:15], s49 offen sc1
L_fpoll:
    s_waitcnt vmcnt(7)
    s_bitcmp1_b32 s53, 0
    s_cbranch_scc0 L_fidle0
    v_cmp_ne_u32 vcc, s47, v67
    v_mov_b32 v67, 0
    s_nop 3
    s_cbranch_vccz L_ftake0
    s_add_u32 s49, s57, 0
    buffer_load_dwordx4 v[64:67], v34, s[12:15], s49 offen sc1
    s_branch L_fnext0
L_ftake0:
    v_mfma_f32_16x16x32_bf16 v[8:11], v[4:7], v[64:67], v[8:11]
    s_bitset0_b32 s53, 0
    s_cmp_eq_u32 s53, 0
    s_nop 4
    s_cbranch_scc1 L_fgot
L_fidle0:
    buffer_load_dword v100, v2, s[12:15], s14 offen
L_fnext0:
    s_waitcnt vmcnt(7)
    s_bitcmp1_b32 s53, 1
    s_cbranch_scc0 L_fidle1
    v_cmp_ne_u32 vcc, s47, v71
    v_mov_b32 v71, 0
    s_nop 3
    s_cbranch_vccz L_ftake1
    s_add_u32 s49, s57, 6144
    buffer_load_dwordx4 v[68:71], v34, s[12:15], s49 offen sc1
    s_branch L_fnext1
L_ftake1:
    v_mfma_f32_16x16x32_bf16 v[8:11], v[4:7], v[68:71], v[8:11]
    s_bitset0_b32 s53, 1
    s_cmp_eq_u32 s53, 0
    s_nop 4
    s_cbranch_scc1 L_fgot
L_fidle1:
    buffer_load_dword v100, v2, s[12:15], s14 offen
L_fnext1:
    s_waitcnt vmcnt(7)
    s_bitcmp1_b32 s53, 2
    s_cbranch_scc0 L_fidle2
    v_cmp_ne_u32 vcc, s47, v75
    v_mov_b32 v75, 0
    s_nop 3
    s_cbranch_vccz L_ftake2
    s_add_u32 s49, s57, 12288
    buffer_load_dwordx4 v[72:75], v34, s[12:15], s49 offen sc1
    s_branch L_fnext2
L_ftake2:
    v_mfma_f32_16x16x32_bf16 v[8:11], v[4:7], v[72:75], v[8:11]
    s_bitset0_b32 s53, 2
    s_cmp_eq_u32 s53, 0
    s_nop 4
    s_cbranch_scc1 L_fgot
L_fidle2:
    buffer_load_dword v100, v2, s[12:15], s14 offen
L_fnext2:
    s_waitcnt vmcnt(7)
    s_bitcmp1_b32 s53, 3
    s_cbranch_scc0 L_fidle3
    v_cmp_ne_u32 vcc, s47, v79
    v_mov_b32 v79, 0
    s_nop 3
    s_cbranch_vccz L_ftake3
    s_add_u32 s49, s57, 18432
    buffer_load_dwordx4 v[76:79], v34, s[12:15], s49 offen sc1
    s_branch L_fnext3
L_ftake3:
    v_mfma_f32_16x16x32_bf16 v[8:11], v[4:7], v[76:79], v[8:11]
    s_bitset0_b32 s53, 3
    s_cmp_eq_u32 s53, 0
    s_nop 4
    s_cbranch_scc1 L_fgot
L_fidle3:
    buffer_load_dword v100, v2, s[12:15], s14 offen
L_fnext3:
    s_waitcnt vmcnt(7)
    s_bitcmp1_b32 s53, 4
    s_cbranch_scc0 L_fidle4
    v_cmp_ne_u32 vcc, s47, v83
    v_mov_b32 v83, 0
    s_nop 3
    s_cbranch_vccz L_ftake4
    s_add_u32 s49, s57, 24576
    buffer_load_dwordx4 v[80:83], v34, s[12:15], s49 offen sc1
    s_branch L_fnext4
L_ftake4:
    v_mfma_f32_16x16x32_bf16 v[8:11], v[4:7], v[80:83], v[8:11]
    s_bitset0_b32 s53, 4
    s_cmp_eq_u32 s53, 0
    s_nop 4
    s_cbranch_scc1 L_fgot
L_fidle4:
    buffer_load_dword v100, v2, s[12:15], s14 offen
L_fnext4:
    s_waitcnt vmcnt(7)
    s_bitcmp1_b32 s53, 5
    s_cbranch_scc0 L_fidle5
    v_cmp_ne_u32 vcc, s47, v87
    v_mov_b32 v87, 0
    s_nop 3
    s_cbranch_vccz L_ftake5
    s_add_u32 s49, s57, 30720
    buffer_load_dwordx4 v[84:87], v34, s[12:15], s49 offen sc1
    s_branch L_fnext5
L_ftake5:
    v_mfma_f32_16x16x32_bf16 v[8:11], v[4:7], v[84:87], v[8:11]
    s_bitset0_b32 s53, 5
    s_cmp_eq_u32 s53, 0
    s_nop 4
    s_cbranch_scc1 L_fgot
L_fidle5:
    buffer_load_dword v100, v2, s[12:15], s14 offen
L_fnext5:
    s_waitcnt vmcnt(7)
    s_bitcmp1_b32 s53, 6
    s_cbranch_scc0 L_fidle6
    v_cmp_ne_u32 vcc, s47, v91
    v_mov_b32 v91, 0
    s_nop 3
    s_cbranch_vccz L_ftake6
    s_add_u32 s49, s57, 36864
    buffer_load_dwordx4 v[88:91], v34, s[12:15], s49 offen sc1
    s_branch L_fnext6
L_ftake6:
    v_mfma_f32_16x16x32_bf16 v[8:11], v[4:7], v[88:91], v[8:11]
    s_bitset0_b32 s53, 6
    s_cmp_eq_u32 s53, 0
    s_nop 4
    s_cbranch_scc1 L_fgot
L_fidle6:
    buffer_load_dword v100, v2, s[12:15], s14 offen
L_fnext6:
    s_waitcnt vmcnt(7)
    s_bitcmp1_b32 s53, 7
    s_cbranch_scc0 L_fidle7
    v_cmp_ne_u32 vcc, s47, v95
    v_mov_b32 v95, 0
    s_nop 3
    s_cbranch_vccz L_ftake7
    s_add_u32 s49, s57, 43008
    buffer_load_dwordx4 v[92:95], v34, s[12:15], s49 offen sc1
    s_branch L_fnext7
L_ftake7:
    v_mfma_f32_16x16x32_bf16 v[8:11], v[4:7], v[92:95], v[8:11]
    s_bitset0_b32 s53, 7
    s_cmp_eq_u32 s53, 0
    s_nop 4
    s_cbranch_scc1 L_fgot
L_fidle7:
    buffer_load_dword v100, v2, s[12:15], s14 offen
L_fnext7:
    s_add_u32 s50, s50, 1
    s_cmp_lt_u32 s50, 1048576
    s_cbranch_scc1 L_fpoll
L_fgot:
    v_cvt_pk_bf16_f32 v8, 0, v8
    v_cvt_pk_bf16_f32 v9, 0, v9
    v_add_f32 v12, v40, v8
    v_add_f32 v13, v41, v9
    v_cvt_pk_bf16_f32 v12, 0, v12
    v_cvt_pk_bf16_f32 v13, 0, v13
    v_mul_f32 v17, v12, v12
    v_add_f32 v16, v12, v13
    v_fmac_f32 v17, v13, v13
    s_nop 0
    v_add_f32_dpp v16, v16, v16 quad_perm:[1,0,3,2] row_mask:0xf bank_mask:0xf
    v_add_f32_dpp v17, v17, v17 quad_perm:[1,0,3,2] row_mask:0xf bank_mask:0xf
    s_nop 0
    v_add_f32_dpp v16, v16, v16 quad_perm:[2,3,0,1] row_mask:0xf bank_mask:0xf
    v_add_f32_dpp v17, v17, v17 quad_perm:[2,3,0,1] row_mask:0xf bank_mask:0xf
    s_nop 0
    v_add_f32_dpp v16, v16, v16 row_half_mirror row_mask:0xf bank_mask:0xf
    v_add_f32_dpp v17, v17, v17 row_half_mirror row_mask:0xf bank_mask:0xf
    s_nop 0
    v_add_f32_dpp v16, v16, v16 row_ror:8 row_mask:0xf bank_mask:0xf
    v_add_f32_dpp v17, v17, v17 row_ror:8 row_mask:0xf bank_mask:0xf
    s_nop 0
    v_add_f32_dpp v16, v16, v16 row_bcast:15 row_mask:0xa bank_mask:0xf
    v_add_f32_dpp v17, v17, v17 row_bcast:15 row_mask:0xa bank_mask:0xf
    s_nop 0
    v_add_f32_dpp v16, v16, v16 row_bcast:31 row_mask:0xc bank_mask:0xf
    v_add_f32_dpp v17, v17, v17 row_bcast:31 row_mask:0xc bank_mask:0xf
    s_mov_b32 exec_lo, 0
    s_mov_b32 exec_hi, 0x80000000
    ds_write_b64 v1, v[16:17] offset:7168
    s_cmp_lg_u32 s99, 0
    s_cbranch_scc1 L_noepoch
    buffer_store_dword v35, v2, s[12:15], 0 offen offset:0 sc1
L_noepoch:
    s_mov_b64 exec, -1
    s_waitcnt lgkmcnt(0)
    s_cmp_lg_u32 s98, 0
    s_cbranch_scc1 L_f_nobar
    s_barrier
L_f_nobar:
    ds_read_b128 v[24:27], v2 offset:7168
    ds_read_b128 v[28:31], v2 offset:7184
    ds_read_b128 v[20:23], v2 offset:7200
    s_waitcnt lgkmcnt(1)
    v_add_f32 v16, v24, v26
    v_add_f32 v17, v25, v27
    v_add_f32 v18, v28, v30
    v_add_f32 v19, v29, v31
    s_waitcnt lgkmcnt(0)
    v_add_f32 v24, v20, v22
    v_add_f32 v25, v21, v23
    v_add_f32 v16, v16, v18
    v_add_f32 v17, v17, v19
    v_add_f32 v16, v16, v24
    v_add_f32 v17, v17, v25
    v_mul_f32 v16, 0x3ae38e39, v16
    v_mul_f32 v17, 0x3ae38e39, v17
    v_cvt_pk_bf16_f32 v18, 0, v16
    v_fma_f32 v17, -v16, v16, v17
    v_sub_f32 v20, v12, v18
    v_max_f32 v17, 0, v17
    v_sub_f32 v21, v13, v18
    v_cvt_pk_bf16_f32 v19, 0, v17
    v_sub_f32 v16, v16, v18
    v_add_f32 v19, 0x3727c5ac, v19
    v_cvt_pk_bf16_f32 v19, 0, v19
    v_sqrt_f32 v19, v19
    v_cvt_pk_bf16_f32 v20, 0, v20
    v_cvt_pk_bf16_f32 v19, 0, v19
    v_rcp_f32 v19, v19
    v_cvt_pk_bf16_f32 v21, 0, v21
    v_mul_f32 v17, v17, v19
    v_mul_f32 v16, v16, v19
    v_mul_f32 v17, v17, v19
    v_mul_f32 v20, v20, v19
    v_cvt_pk_bf16_f32 v17, 0, v17
    v_mul_f32 v21, v21, v19
    v_add_f32 v17, 0x3727c5ac, v17
    v_cvt_pk_bf16_f32 v16, 0, v16
    v_cvt_pk_bf16_f32 v17, 0, v17
    v_cvt_pk_bf16_f32 v20, 0, v20
    v_sqrt_f32 v17, v17
    v_cvt_pk_bf16_f32 v21, 0, v21
    v_cvt_pk_bf16_f32 v17, 0, v17
    v_sub_f32 v20, v20, v16
    v_rcp_f32 v17, v17
    v_sub_f32 v21, v21, v16
    v_cvt_pk_bf16_f32 v20, 0, v20
    v_cvt_pk_bf16_f32 v21, 0, v21
    v_mul_f32 v20, v20, v17
    v_mul_f32 v21, v21, v17
    v_cvt_pk_bf16_f32 v20, 0, v20
    v_cvt_pk_bf16_f32 v21, 0, v21
    v_ashrrev_i32 v44, 31, v20
    v_bfe_u32 v24, v20, 15, 16
    v_ashrrev_i32 v45, 31, v21
    v_bfe_u32 v25, v21, 15, 16
    v_and_b32 v44, s56, v44
    v_and_b32 v45, s56, v45
    v_add3_u32 v44, v44, v24, s54
    v_add3_u32 v45, v45, v25, s54
    ds_read_u16_d16_hi v48, v44
    ds_read_u16_d16_hi v49, v45
    v_subrev_u32 v24, 28672, v24
    v_subrev_u32 v25, 28672, v25
    s_mov_b64 exec, s[88:89]
    v_cmp_le_u32 s[90:91], s56, v24
    v_cmp_le_u32 s[92:93], s56, v25
    s_nop 1
    s_or_b64 s[86:87], s[90:91], s[92:93]
    s_nop 0
    s_cbranch_scc1 L_slow
L_slow_ret:
    s_waitcnt lgkmcnt(0)
    v_add_f32 v12, v12, v48
    v_add_f32 v13, v13, v49
    v_cvt_pk_bf16_f32 v16, v12, v13
    s_cmp_lg_u32 s98, 0
    s_cbranch_scc1 L_final_real
    buffer_store_dword v16, v3, s[8:11], s52 offen
    s_mov_b64 exec, -1
L_end:
    s_endpgm
L_slow:
    s_cmp_lg_u32 s98, 0
    s_cbranch_scc1 L_slow_ret
    s_mov_b64 exec, -1
    v_mov_b32 v28, 0xc0135761
    v_mov_b32 v30, 0xbdd2d3e8
    v_mov_b32 v32, 1.0
    v_mov_b32 v29, 0xc0135761
    v_mov_b32 v31, 0xbdd2d3e8
    v_mov_b32 v33, 1.0
    s_load_dword s69, s[34:35], 0
    v_lshlrev_b32 v1, 4, v0
    s_waitcnt lgkmcnt(0)
    s_lshl_b32 s69, s69, 16
L_slow_r0:
    s_cmp_eq_u64 s[90:91], 0
    s_cbranch_scc1 L_slow_n0
    s_ff1_i32_b64 s54, s[90:91]
    s_bitset0_b64 s[90:91], s54
    v_readlane_b32 s58, v20, s54
    v_mov_b32 v26, 0
    v_mov_b32 v27, 0
    s_mov_b32 s53, 0
    s_nop 1
L_slow_l0:
    s_mov_b32 s4, s28
    s_mov_b32 s5, s29
    s_mov_b32 s6, 9216
    s_mov_b32 s7, 0x20000
    buffer_load_dwordx4 v[64:67], v1, s[4:7], s53 offen
    s_mov_b32 s4, s30
    s_mov_b32 s5, s31
    s_mov_b32 s6, 9216
    s_mov_b32 s7, 0x20000
    buffer_load_dwordx4 v[68:71], v1, s[4:7], s53 offen
    s_mov_b32 s4, s32
    s_mov_b32 s5, s33
    s_mov_b32 s6, 9216
    s_mov_b32 s7, 0x20000
    buffer_load_dwordx4 v[72:75], v1, s[4:7], s53 offen
    s_waitcnt vmcnt(0)
    v_lshlrev_b32 v80, 16, v64
    v_and_b32 v81, 0xffff0000, v64
    v_lshlrev_b32 v82, 16, v65
    v_and_b32 v83, 0xffff0000, v65
    v_lshlrev_b32 v84, 16, v66
    v_and_b32 v85, 0xffff0000, v66
    v_lshlrev_b32 v86, 16, v67
    v_and_b32 v87, 0xffff0000, v67
    v_lshlrev_b32 v88, 16, v68
    v_and_b32 v89, 0xffff0000, v68
    v_lshlrev_b32 v90, 16, v69
    v_and_b32 v91, 0xffff0000, v69
    v_lshlrev_b32 v92, 16, v70
    v_and_b32 v93, 0xffff0000, v70
    v_lshlrev_b32 v94, 16, v71
    v_and_b32 v95, 0xffff0000, v71
    v_lshlrev_b32 v96, 16, v72
    v_and_b32 v97, 0xffff0000, v72
    v_lshlrev_b32 v98, 16, v73
    v_and_b32 v99, 0xffff0000, v73
    v_lshlrev_b32 v100, 16, v74
    v_and_b32 v101, 0xffff0000, v74
    v_lshlrev_b32 v102, 16, v75
    v_and_b32 v103, 0xffff0000, v75
    v_pk_mul_f32 v[104:105], s[58:59], v[80:81] op_sel_hi:[0,1]
    v_pk_mul_f32 v[108:109], s[58:59], v[82:83] op_sel_hi:[0,1]
    v_pk_mul_f32 v[112:113], s[58:59], v[84:85] op_sel_hi:[0,1]
    v_pk_mul_f32 v[116:117], s[58:59], v[86:87] op_sel_hi:[0,1]
    v_cvt_pk_bf16_f32 v104, 0, v104
    v_cvt_pk_bf16_f32 v105, 0, v105
    v_cvt_pk_bf16_f32 v108, 0, v108
    v_cvt_pk_bf16_f32 v109, 0, v109
    v_cvt_pk_bf16_f32 v112, 0, v112
    v_cvt_pk_bf16_f32 v113, 0, v113
    v_cvt_pk_bf16_f32 v116, 0, v116
    v_cvt_pk_bf16_f32 v117, 0, v117
    v_pk_add_f32 v[104:105], v[104:105], v[88:89]
    v_pk_add_f32 v[108:109], v[108:109], v[90:91]
    v_pk_add_f32 v[112:113], v[112:113], v[92:93]
    v_pk_add_f32 v[116:117], v[116:117], v[94:95]
    v_cvt_pk_bf16_f32 v104, 0, v104
    v_cvt_pk_bf16_f32 v105, 0, v105
    v_cvt_pk_bf16_f32 v108, 0, v108
    v_cvt_pk_bf16_f32 v109, 0, v109
    v_cvt_pk_bf16_f32 v112, 0, v112
    v_cvt_pk_bf16_f32 v113, 0, v113
    v_cvt_pk_bf16_f32 v116, 0, v116
    v_cvt_pk_bf16_f32 v117, 0, v117
    v_pk_mul_f32 v[106:107], v[104:105], v[104:105]
    v_pk_mul_f32 v[110:111], v[108:109], v[108:109]
    v_pk_mul_f32 v[114:115], v[112:113], v[112:113]
    v_pk_mul_f32 v[118:119], v[116:117], v[116:117]
    v_pk_fma_f32 v[106:107], v[106:107], v[30:31], v[28:29]
    v_pk_fma_f32 v[110:111], v[110:111], v[30:31], v[28:29]
    v_pk_fma_f32 v[114:115], v[114:115], v[30:31], v[28:29]
    v_pk_fma_f32 v[118:119], v[118:119], v[30:31], v[28:29]
    v_pk_mul_f32 v[106:107], v[106:107], v[104:105]
    v_pk_mul_f32 v[110:111], v[110:111], v[108:109]
    v_pk_mul_f32 v[114:115], v[114:115], v[112:113]
    v_pk_mul_f32 v[118:119], v[118:119], v[116:117]
    v_exp_f32 v106, v106
    v_exp_f32 v107, v107
    v_exp_f32 v110, v110
    v_exp_f32 v111, v111
    v_exp_f32 v114, v114
    v_exp_f32 v115, v115
    v_exp_f32 v118, v118
    v_exp_f32 v119, v119
    v_pk_add_f32 v[106:107], v[106:107], v[32:33]
    v_pk_add_f32 v[110:111], v[110:111], v[32:33]
    v_pk_add_f32 v[114:115], v[114:115], v[32:33]
    v_pk_add_f32 v[118:119], v[118:119], v[32:33]
    v_rcp_f32 v106, v106
    v_rcp_f32 v107, v107
    v_rcp_f32 v110, v110
    v_rcp_f32 v111, v111
    v_rcp_f32 v114, v114
    v_rcp_f32 v115, v115
    v_rcp_f32 v118, v118
    v_rcp_f32 v119, v119
    v_pk_mul_f32 v[106:107], v[106:107], v[104:105]
    v_pk_mul_f32 v[110:111], v[110:111], v[108:109]
    v_pk_mul_f32 v[114:115], v[114:115], v[112:113]
    v_pk_mul_f32 v[118:119], v[118:119], v[116:117]
    v_cvt_pk_bf16_f32 v106, 0, v106
    v_cvt_pk_bf16_f32 v107, 0, v107
    v_cvt_pk_bf16_f32 v110, 0, v110
    v_cvt_pk_bf16_f32 v111, 0, v111
    v_cvt_pk_bf16_f32 v114, 0, v114
    v_cvt_pk_bf16_f32 v115, 0, v115
    v_cvt_pk_bf16_f32 v118, 0, v118
    v_cvt_pk_bf16_f32 v119, 0, v119
    v_pk_fma_f32 v[26:27], v[106:107], v[96:97], v[26:27]
    v_pk_fma_f32 v[26:27], v[110:111], v[98:99], v[26:27]
    v_pk_fma_f32 v[26:27], v[114:115], v[100:101], v[26:27]
    v_pk_fma_f32 v[26:27], v[118:119], v[102:103], v[26:27]
    s_add_u32 s53, s53, 1024
    s_cmp_lt_u32 s53, 9216
    s_cbranch_scc1 L_slow_l0
    v_add_f32 v26, v26, v27
    s_nop 1
    v_add_f32_dpp v26, v26, v26 quad_perm:[1,0,3,2] row_mask:0xf bank_mask:0xf
    s_nop 1
    v_add_f32_dpp v26, v26, v26 quad_perm:[2,3,0,1] row_mask:0xf bank_mask:0xf
    s_nop 1
    v_add_f32_dpp v26, v26, v26 row_half_mirror row_mask:0xf bank_mask:0xf
    s_nop 1
    v_add_f32_dpp v26, v26, v26 row_ror:8 row_mask:0xf bank_mask:0xf
    v_mov_b32 v27, v26
    s_nop 1
    v_permlane16_swap_b32 v26, v27
    v_add_f32 v26, v26, v27
    v_mov_b32 v27, v26
    s_nop 1
    v_permlane32_swap_b32 v26, v27
    v_add_f32 v26, v26, v27
    v_cvt_pk_bf16_f32 v26, 0, v26
    v_add_f32 v26, s69, v26
    v_cvt_pk_bf16_f32 v26, 0, v26
    s_lshl_b64 exec, 1, s54
    v_mov_b32 v48, v26
    s_mov_b64 exec, -1
    s_branch L_slow_r0
L_slow_n0:
L_slow_r1:
    s_cmp_eq_u64 s[92:93], 0
    s_cbranch_scc1 L_slow_n1
    s_ff1_i32_b64 s54, s[92:93]
    s_bitset0_b64 s[92:93], s54
    v_readlane_b32 s58, v21, s54
    v_mov_b32 v26, 0
    v_mov_b32 v27, 0
    s_mov_b32 s53, 0
    s_nop 1
L_slow_l1:
    s_mov_b32 s4, s28
    s_mov_b32 s5, s29
    s_mov_b32 s6, 9216
    s_mov_b32 s7, 0x20000
    buffer_load_dwordx4 v[64:67], v1, s[4:7], s53 offen
    s_mov_b32 s4, s30
    s_mov_b32 s5, s31
    s_mov_b32 s6, 9216
    s_mov_b32 s7, 0x20000
    buffer_load_dwordx4 v[68:71], v1, s[4:7], s53 offen
    s_mov_b32 s4, s32
    s_mov_b32 s5, s33
    s_mov_b32 s6, 9216
    s_mov_b32 s7, 0x20000
    buffer_load_dwordx4 v[72:75], v1, s[4:7], s53 offen
    s_waitcnt vmcnt(0)
    v_lshlrev_b32 v80, 16, v64
    v_and_b32 v81, 0xffff0000, v64
    v_lshlrev_b32 v82, 16, v65
    v_and_b32 v83, 0xffff0000, v65
    v_lshlrev_b32 v84, 16, v66
    v_and_b32 v85, 0xffff0000, v66
    v_lshlrev_b32 v86, 16, v67
    v_and_b32 v87, 0xffff0000, v67
    v_lshlrev_b32 v88, 16, v68
    v_and_b32 v89, 0xffff0000, v68
    v_lshlrev_b32 v90, 16, v69
    v_and_b32 v91, 0xffff0000, v69
    v_lshlrev_b32 v92, 16, v70
    v_and_b32 v93, 0xffff0000, v70
    v_lshlrev_b32 v94, 16, v71
    v_and_b32 v95, 0xffff0000, v71
    v_lshlrev_b32 v96, 16, v72
    v_and_b32 v97, 0xffff0000, v72
    v_lshlrev_b32 v98, 16, v73
    v_and_b32 v99, 0xffff0000, v73
    v_lshlrev_b32 v100, 16, v74
    v_and_b32 v101, 0xffff0000, v74
    v_lshlrev_b32 v102, 16, v75
    v_and_b32 v103, 0xffff0000, v75
    v_pk_mul_f32 v[104:105], s[58:59], v[80:81] op_sel_hi:[0,1]
    v_pk_mul_f32 v[108:109], s[58:59], v[82:83] op_sel_hi:[0,1]
    v_pk_mul_f32 v[112:113], s[58:59], v[84:85] op_sel_hi:[0,1]
    v_pk_mul_f32 v[116:117], s[58:59], v[86:87] op_sel_hi:[0,1]
    v_cvt_pk_bf16_f32 v104, 0, v104
    v_cvt_pk_bf16_f32 v105, 0, v105
    v_cvt_pk_bf16_f32 v108, 0, v108
    v_cvt_pk_bf16_f32 v109, 0, v109
    v_cvt_pk_bf16_f32 v112, 0, v112
    v_cvt_pk_bf16_f32 v113, 0, v113
    v_cvt_pk_bf16_f32 v116, 0, v116
    v_cvt_pk_bf16_f32 v117, 0, v117
    v_pk_add_f32 v[104:105], v[104:105], v[88:89]
    v_pk_add_f32 v[108:109], v[108:109], v[90:91]
    v_pk_add_f32 v[112:113], v[112:113], v[92:93]
    v_pk_add_f32 v[116:117], v[116:117], v[94:95]
    v_cvt_pk_bf16_f32 v104, 0, v104
    v_cvt_pk_bf16_f32 v105, 0, v105
    v_cvt_pk_bf16_f32 v108, 0, v108
    v_cvt_pk_bf16_f32 v109, 0, v109
    v_cvt_pk_bf16_f32 v112, 0, v112
    v_cvt_pk_bf16_f32 v113, 0, v113
    v_cvt_pk_bf16_f32 v116, 0, v116
    v_cvt_pk_bf16_f32 v117, 0, v117
    v_pk_mul_f32 v[106:107], v[104:105], v[104:105]
    v_pk_mul_f32 v[110:111], v[108:109], v[108:109]
    v_pk_mul_f32 v[114:115], v[112:113], v[112:113]
    v_pk_mul_f32 v[118:119], v[116:117], v[116:117]
    v_pk_fma_f32 v[106:107], v[106:107], v[30:31], v[28:29]
    v_pk_fma_f32 v[110:111], v[110:111], v[30:31], v[28:29]
    v_pk_fma_f32 v[114:115], v[114:115], v[30:31], v[28:29]
    v_pk_fma_f32 v[118:119], v[118:119], v[30:31], v[28:29]
    v_pk_mul_f32 v[106:107], v[106:107], v[104:105]
    v_pk_mul_f32 v[110:111], v[110:111], v[108:109]
    v_pk_mul_f32 v[114:115], v[114:115], v[112:113]
    v_pk_mul_f32 v[118:119], v[118:119], v[116:117]
    v_exp_f32 v106, v106
    v_exp_f32 v107, v107
    v_exp_f32 v110, v110
    v_exp_f32 v111, v111
    v_exp_f32 v114, v114
    v_exp_f32 v115, v115
    v_exp_f32 v118, v118
    v_exp_f32 v119, v119
    v_pk_add_f32 v[106:107], v[106:107], v[32:33]
    v_pk_add_f32 v[110:111], v[110:111], v[32:33]
    v_pk_add_f32 v[114:115], v[114:115], v[32:33]
    v_pk_add_f32 v[118:119], v[118:119], v[32:33]
    v_rcp_f32 v106, v106
    v_rcp_f32 v107, v107
    v_rcp_f32 v110, v110
    v_rcp_f32 v111, v111
    v_rcp_f32 v114, v114
    v_rcp_f32 v115, v115
    v_rcp_f32 v118, v118
    v_rcp_f32 v119, v119
    v_pk_mul_f32 v[106:107], v[106:107], v[104:105]
    v_pk_mul_f32 v[110:111], v[110:111], v[108:109]
    v_pk_mul_f32 v[114:115], v[114:115], v[112:113]
    v_pk_mul_f32 v[118:119], v[118:119], v[116:117]
    v_cvt_pk_bf16_f32 v106, 0, v106
    v_cvt_pk_bf16_f32 v107, 0, v107
    v_cvt_pk_bf16_f32 v110, 0, v110
    v_cvt_pk_bf16_f32 v111, 0, v111
    v_cvt_pk_bf16_f32 v114, 0, v114
    v_cvt_pk_bf16_f32 v115, 0, v115
    v_cvt_pk_bf16_f32 v118, 0, v118
    v_cvt_pk_bf16_f32 v119, 0, v119
    v_pk_fma_f32 v[26:27], v[106:107], v[96:97], v[26:27]
    v_pk_fma_f32 v[26:27], v[110:111], v[98:99], v[26:27]
    v_pk_fma_f32 v[26:27], v[114:115], v[100:101], v[26:27]
    v_pk_fma_f32 v[26:27], v[118:119], v[102:103], v[26:27]
    s_add_u32 s53, s53, 1024
    s_cmp_lt_u32 s53, 9216
    s_cbranch_scc1 L_slow_l1
    v_add_f32 v26, v26, v27
    s_nop 1
    v_add_f32_dpp v26, v26, v26 quad_perm:[1,0,3,2] row_mask:0xf bank_mask:0xf
    s_nop 1
    v_add_f32_dpp v26, v26, v26 quad_perm:[2,3,0,1] row_mask:0xf bank_mask:0xf
    s_nop 1
    v_add_f32_dpp v26, v26, v26 row_half_mirror row_mask:0xf bank_mask:0xf
    s_nop 1
    v_add_f32_dpp v26, v26, v26 row_ror:8 row_mask:0xf bank_mask:0xf
    v_mov_b32 v27, v26
    s_nop 1
    v_permlane16_swap_b32 v26, v27
    v_add_f32 v26, v26, v27
    v_mov_b32 v27, v26
    s_nop 1
    v_permlane32_swap_b32 v26, v27
    v_add_f32 v26, v26, v27
    v_cvt_pk_bf16_f32 v26, 0, v26
    v_add_f32 v26, s69, v26
    v_cvt_pk_bf16_f32 v26, 0, v26
    s_lshl_b64 exec, 1, s54
    v_mov_b32 v49, v26
    s_mov_b64 exec, -1
    s_branch L_slow_r1
L_slow_n1:
    s_mov_b64 exec, s[88:89]
    s_branch L_slow_ret
L_code_end:
.section .rodata,"a"
.p2align 6
.amdhsa_kernel sequential_preLN__gqa_block_cached__mixer_token_mlp__decode_kernel
  .amdhsa_next_free_vgpr 256
  .amdhsa_next_free_sgpr 102
  .amdhsa_accum_offset 256
  .amdhsa_group_segment_fixed_size 0
  .amdhsa_kernarg_size 104
  .amdhsa_user_sgpr_count 2
  .amdhsa_user_sgpr_kernarg_segment_ptr 1
  .amdhsa_system_sgpr_workgroup_id_x 1
  .amdhsa_float_denorm_mode_32 3
.end_amdhsa_kernel
```
